```python
import torch

def _softmax(x, axis=-1):
    return torch.softmax(x, dim=axis)

def _gelu(x):
    return torch.nn.functional.gelu(x, approximate='tanh')

def _silu(x):
    return torch.nn.functional.silu(x)

def _sigmoid(x):
    return torch.sigmoid(x)

def _layernorm(x, axis=-1, eps=1e-05):
    m = x.mean(dim=axis, keepdim=True)
    v = x.var(dim=axis, keepdim=True, unbiased=False)
    return (x - m) / torch.sqrt(v + eps)

def _scatter_add(tgt, idx, src, axis=0):
    return tgt.clone().index_add_(axis, idx, src)

def _segment_sum(src, seg, n):
    out = torch.zeros((n,) + src.shape[1:], dtype=src.dtype)
    return out.index_add_(0, seg, src)

def _pad(x, pw):
    flat = tuple((v for pair in reversed(pw) for v in pair))
    return torch.nn.functional.pad(x, flat)
kernel_name = 'standalone__mixer_gmlp__prompt'

def setup_inputs():

    _w = lambda a: (lambda t: t.to(torch.bfloat16) if t.is_floating_point() else t)(torch.as_tensor(a))
    B, S, D, F = (1, 2048, 576, 4608)
    Fh = F // 2
    return {'x': _w((lambda *s: torch.randn(*s, dtype=torch.bfloat16) * 0.05)(B, S, D)), 'w_in': _w((lambda *s: torch.randn(*s, dtype=torch.bfloat16) * 0.4)(D, 2 * Fh)), 'w_sp': _w(0.01 * (lambda *s: torch.randn(*s, dtype=torch.bfloat16) * 0.4)(S, S)), 'b_sp': _w(1.0 + 0.01 * (lambda *s: torch.randn(*s, dtype=torch.bfloat16) * 0.05)(S)), 'w_out': _w((lambda *s: torch.randn(*s, dtype=torch.bfloat16) * 0.05)(Fh, D))}

def reference(x, w_in, w_sp, b_sp, w_out):
    B, S, D = x.shape
    F = w_in.shape[-1]
    Fh = F // 2
    z = _gelu(torch.einsum('bsd,df->bsf', x, w_in))
    z1 = z[..., :Fh].clone()
    z2 = _layernorm(z[..., Fh:], axis=-1)
    g = torch.einsum('ts,bsf->btf', w_sp, z2) + b_sp[None, :, None]
    return torch.einsum('bsf,fd->bsd', z1 * g, w_out)
```

```asm
; @launch grid=(256,1,1) block=(512,1,1) lds=147456
.amdgcn_target "amdgcn-amd-amdhsa--gfx950"
.text
    .globl standalone__mixer_gmlp__prompt_kernel
    .p2align 8
    .type standalone__mixer_gmlp__prompt_kernel,@function
standalone__mixer_gmlp__prompt_kernel:
    s_cmp_ge_u32 s2, 256
    s_cbranch_scc1 k_end
    s_load_dwordx16 s[4:19], s[0:1], 0
    s_and_b32 s20, s2, 7
    s_lshr_b32 s21, s2, 3
    s_lshr_b32 s52, s20, 1
    s_and_b32 s22, s20, 1
    s_lshl_b32 s22, s22, 3
    s_and_b32 s53, s21, 7
    s_add_u32 s22, s22, s53
    s_lshr_b32 s54, s21, 3
    s_lshl_b32 s23, s52, 2
    s_add_u32 s23, s23, s54
    v_and_b32 v1, 63, v0
    v_lshrrev_b32 v2, 6, v0
    s_nop 0
    v_readfirstlane_b32 s26, v2
    v_and_b32 v2, 15, v1
    v_lshrrev_b32 v3, 4, v1
    s_and_b32 s27, s26, 3
    s_cmp_ge_u32 s26, 4
    s_cbranch_scc1 k_loader
    v_lshrrev_b32 v4, 2, v2
    v_lshlrev_b32 v4, 3, v4
    v_and_b32 v5, 3, v2
    v_add_u32 v240, v4, v5
    s_lshl_b32 s29, s27, 5
    v_add_u32 v4, s29, v240
    v_lshlrev_b32 v4, 7, v4
    v_lshrrev_b32 v5, 1, v2
    v_xor_b32 v5, v5, v3
    v_lshl_add_u32 v4, v5, 4, v4
    v_mov_b32 v241, v4
    v_xor_b32 v5, 64, v4
    v_lshrrev_b32 v6, 2, v2
    v_mul_u32_u24 v6, 288, v6
    v_mul_u32_u24 v7, 2432, v3
    v_add_u32 v6, v6, v7
    v_and_b32 v7, 3, v1
    v_lshl_add_u32 v6, v7, 3, v6
    v_add_u32 v6, 16384, v6
    v_lshlrev_b32 v7, 4, v1
    v_mov_b64 v[8:9], 0
    v_mov_b64 v[10:11], 0
    v_mov_b64 v[12:13], 0
    v_mov_b64 v[14:15], 0
    v_mov_b64 v[16:17], 0
    v_mov_b64 v[18:19], 0
    v_mov_b64 v[20:21], 0
    v_mov_b64 v[22:23], 0
    v_mov_b64 v[24:25], 0
    v_mov_b64 v[26:27], 0
    v_mov_b64 v[28:29], 0
    v_mov_b64 v[30:31], 0
    v_mov_b64 v[32:33], 0
    v_mov_b64 v[34:35], 0
    v_mov_b64 v[36:37], 0
    v_mov_b64 v[38:39], 0
    v_mov_b64 v[40:41], 0
    v_mov_b64 v[42:43], 0
    v_mov_b64 v[44:45], 0
    v_mov_b64 v[46:47], 0
    v_mov_b64 v[48:49], 0
    v_mov_b64 v[50:51], 0
    v_mov_b64 v[52:53], 0
    v_mov_b64 v[54:55], 0
    v_mov_b64 v[56:57], 0
    v_mov_b64 v[58:59], 0
    v_mov_b64 v[60:61], 0
    v_mov_b64 v[62:63], 0
    v_mov_b64 v[64:65], 0
    v_mov_b64 v[66:67], 0
    v_mov_b64 v[68:69], 0
    v_mov_b64 v[70:71], 0
    v_mov_b64 v[72:73], 0
    v_mov_b64 v[74:75], 0
    v_mov_b64 v[76:77], 0
    v_mov_b64 v[78:79], 0
    v_mov_b64 v[80:81], 0
    v_mov_b64 v[82:83], 0
    v_mov_b64 v[84:85], 0
    v_mov_b64 v[86:87], 0
    v_mov_b64 v[88:89], 0
    v_mov_b64 v[90:91], 0
    v_mov_b64 v[92:93], 0
    v_mov_b64 v[94:95], 0
    v_mov_b64 v[96:97], 0
    v_mov_b64 v[98:99], 0
    v_mov_b64 v[100:101], 0
    v_mov_b64 v[102:103], 0
    v_mov_b64 v[104:105], 0
    v_mov_b64 v[106:107], 0
    v_mov_b64 v[108:109], 0
    v_mov_b64 v[110:111], 0
    v_mov_b64 v[112:113], 0
    v_mov_b64 v[114:115], 0
    v_mov_b64 v[116:117], 0
    v_mov_b64 v[118:119], 0
    v_mov_b64 v[120:121], 0
    v_mov_b64 v[122:123], 0
    v_mov_b64 v[124:125], 0
    v_mov_b64 v[126:127], 0
    v_mov_b64 v[128:129], 0
    v_mov_b64 v[130:131], 0
    v_mov_b64 v[132:133], 0
    v_mov_b64 v[134:135], 0
    v_mov_b64 v[136:137], 0
    v_mov_b64 v[138:139], 0
    v_mov_b64 v[140:141], 0
    v_mov_b64 v[142:143], 0
    v_mov_b64 v[144:145], 0
    v_mov_b64 v[146:147], 0
    v_mov_b64 v[148:149], 0
    v_mov_b64 v[150:151], 0
    s_mov_b32 s30, 0
    s_mov_b32 s31, 0
    s_mov_b32 s40, 0xbdd2d3e8
    s_mov_b32 s41, 0xbdd2d3e8
    s_mov_b32 s42, 0xc0135761
    s_mov_b32 s43, 36864
    s_waitcnt lgkmcnt(0)
    s_mov_b32 s48, s16
    s_mov_b32 s49, s17
    s_mov_b32 s50, 0x100
    s_mov_b32 s51, 0x20000
    s_mov_b32 s64, s10
    s_mov_b32 s65, s11
    s_mov_b32 s66, 0x1000
    s_mov_b32 s67, 0x20000
    s_cmp_lg_u32 s27, 0
    s_cbranch_scc1 k1_nocp
    s_cmp_lg_u32 s2, 0
    s_cbranch_scc1 k1_nonon
    s_memrealtime s[60:61]
    s_waitcnt lgkmcnt(0)
    s_or_b32 s60, s60, 1
    v_mov_b32 v243, s60
    s_mov_b64 exec, 1
    buffer_store_dword v243, off, s[48:51], 0 sc1
    s_mov_b64 exec, -1
k1_nonon:
    s_getpc_b64 s[60:61]
cp_l:
    s_add_u32 s60, s60, standalone__mixer_gmlp__prompt_kernel-cp_l
    s_addc_u32 s61, s61, -1
    v_lshlrev_b32 v244, 7, v1
    global_load_dword v245, v244, s[60:61]
    v_add_u32 v244, 8192, v244
    global_load_dword v245, v244, s[60:61]
    v_add_u32 v244, 8192, v244
    global_load_dword v245, v244, s[60:61]
k1_nocp:
    s_lshl_b32 s37, s22, 7
    s_add_u32 s37, s37, s29
    v_add_u32 v244, s37, v240
    v_lshlrev_b32 v244, 1, v244
    buffer_load_ushort v246, v244, s[64:67], 0 offen
    buffer_load_ushort v247, v244, s[64:67], 0 offen offset:8
    s_barrier
    s_setprio 1
    ds_read_b128 v[152:155], v4 offset:0
    ds_read_b128 v[156:159], v4 offset:512
    ds_read_b64_tr_b16 v[168:169], v6 offset:0
    ds_read_b64_tr_b16 v[170:171], v6 offset:1152
    ds_read_b64_tr_b16 v[172:173], v6 offset:32
    ds_read_b64_tr_b16 v[174:175], v6 offset:1184
    ds_read_b64_tr_b16 v[176:177], v6 offset:64
    ds_read_b64_tr_b16 v[178:179], v6 offset:1216
    ds_read_b64_tr_b16 v[180:181], v6 offset:96
    ds_read_b64_tr_b16 v[182:183], v6 offset:1248
    ds_read_b64_tr_b16 v[184:185], v6 offset:128
    ds_read_b64_tr_b16 v[186:187], v6 offset:1280
    ds_read_b64_tr_b16 v[188:189], v6 offset:160
    ds_read_b64_tr_b16 v[190:191], v6 offset:1312
    ds_read_b64_tr_b16 v[192:193], v6 offset:192
    ds_read_b64_tr_b16 v[194:195], v6 offset:1344
    ds_read_b64_tr_b16 v[196:197], v6 offset:224
    ds_read_b64_tr_b16 v[198:199], v6 offset:1376
    ds_read_b64_tr_b16 v[200:201], v6 offset:256
    ds_read_b64_tr_b16 v[202:203], v6 offset:1408
    s_waitcnt lgkmcnt(0)
k1_loop0:
    s_waitcnt lgkmcnt(12)
    v_mfma_f32_16x16x32_bf16 v[8:11], v[152:155], v[168:171], v[8:11]
    ds_read_b128 v[160:163], v5 offset:0
    v_mfma_f32_16x16x32_bf16 v[44:47], v[156:159], v[168:171], v[44:47]
    ds_read_b128 v[164:167], v5 offset:512
    v_mfma_f32_16x16x32_bf16 v[12:15], v[152:155], v[172:175], v[12:15]
    ds_read_b64_tr_b16 v[168:169], v6 offset:9728
    v_mfma_f32_16x16x32_bf16 v[48:51], v[156:159], v[172:175], v[48:51]
    ds_read_b64_tr_b16 v[170:171], v6 offset:10880
    v_mfma_f32_16x16x32_bf16 v[16:19], v[152:155], v[176:179], v[16:19]
    ds_read_b64_tr_b16 v[172:173], v6 offset:9760
    v_mfma_f32_16x16x32_bf16 v[52:55], v[156:159], v[176:179], v[52:55]
    ds_read_b64_tr_b16 v[174:175], v6 offset:10912
    s_waitcnt lgkmcnt(12)
    v_mfma_f32_16x16x32_bf16 v[20:23], v[152:155], v[180:183], v[20:23]
    ds_read_b64_tr_b16 v[176:177], v6 offset:9792
    v_mfma_f32_16x16x32_bf16 v[56:59], v[156:159], v[180:183], v[56:59]
    ds_read_b64_tr_b16 v[178:179], v6 offset:10944
    v_mfma_f32_16x16x32_bf16 v[24:27], v[152:155], v[184:187], v[24:27]
    ds_read_b64_tr_b16 v[180:181], v6 offset:9824
    v_mfma_f32_16x16x32_bf16 v[60:63], v[156:159], v[184:187], v[60:63]
    ds_read_b64_tr_b16 v[182:183], v6 offset:10976
    v_mfma_f32_16x16x32_bf16 v[28:31], v[152:155], v[188:191], v[28:31]
    ds_read_b64_tr_b16 v[184:185], v6 offset:9856
    v_mfma_f32_16x16x32_bf16 v[64:67], v[156:159], v[188:191], v[64:67]
    ds_read_b64_tr_b16 v[186:187], v6 offset:11008
    s_waitcnt lgkmcnt(12)
    v_mfma_f32_16x16x32_bf16 v[32:35], v[152:155], v[192:195], v[32:35]
    ds_read_b64_tr_b16 v[188:189], v6 offset:9888
    v_mfma_f32_16x16x32_bf16 v[68:71], v[156:159], v[192:195], v[68:71]
    ds_read_b64_tr_b16 v[190:191], v6 offset:11040
    v_mfma_f32_16x16x32_bf16 v[36:39], v[152:155], v[196:199], v[36:39]
    ds_read_b64_tr_b16 v[192:193], v6 offset:9920
    v_mfma_f32_16x16x32_bf16 v[72:75], v[156:159], v[196:199], v[72:75]
    ds_read_b64_tr_b16 v[194:195], v6 offset:11072
    v_mfma_f32_16x16x32_bf16 v[40:43], v[152:155], v[200:203], v[40:43]
    ds_read_b64_tr_b16 v[196:197], v6 offset:9952
    v_mfma_f32_16x16x32_bf16 v[76:79], v[156:159], v[200:203], v[76:79]
    ds_read_b64_tr_b16 v[198:199], v6 offset:11104
    s_waitcnt lgkmcnt(10)
    v_mfma_f32_16x16x32_bf16 v[8:11], v[160:163], v[168:171], v[8:11]
    ds_read_b64_tr_b16 v[200:201], v6 offset:9984
    v_mfma_f32_16x16x32_bf16 v[44:47], v[164:167], v[168:171], v[44:47]
    ds_read_b64_tr_b16 v[202:203], v6 offset:11136
    v_mfma_f32_16x16x32_bf16 v[12:15], v[160:163], v[172:175], v[12:15]
    s_add_u32 s30, s30, 36864
    s_cmp_eq_u32 s30, 147456
    s_cselect_b32 s30, 0, s30
    s_cselect_b32 s29, -110592, s43
    v_add_u32 v4, s29, v4
    v_mfma_f32_16x16x32_bf16 v[48:51], v[164:167], v[172:175], v[48:51]
    v_add_u32 v5, s29, v5
    v_mfma_f32_16x16x32_bf16 v[16:19], v[160:163], v[176:179], v[16:19]
    v_add_u32 v6, s29, v6
    v_mfma_f32_16x16x32_bf16 v[52:55], v[164:167], v[176:179], v[52:55]
    s_waitcnt lgkmcnt(6)
    v_mfma_f32_16x16x32_bf16 v[20:23], v[160:163], v[180:183], v[20:23]
    v_mfma_f32_16x16x32_bf16 v[56:59], v[164:167], v[180:183], v[56:59]
    s_waitcnt lgkmcnt(0)
    s_barrier
    v_mfma_f32_16x16x32_bf16 v[24:27], v[160:163], v[184:187], v[24:27]
    ds_read_b64_tr_b16 v[168:169], v6 offset:0
    ds_read_b64_tr_b16 v[170:171], v6 offset:1152
    v_mfma_f32_16x16x32_bf16 v[60:63], v[164:167], v[184:187], v[60:63]
    ds_read_b128 v[152:155], v4 offset:0
    ds_read_b128 v[156:159], v4 offset:512
    v_mfma_f32_16x16x32_bf16 v[28:31], v[160:163], v[188:191], v[28:31]
    ds_read_b64_tr_b16 v[172:173], v6 offset:32
    ds_read_b64_tr_b16 v[174:175], v6 offset:1184
    v_mfma_f32_16x16x32_bf16 v[64:67], v[164:167], v[188:191], v[64:67]
    ds_read_b64_tr_b16 v[176:177], v6 offset:64
    ds_read_b64_tr_b16 v[178:179], v6 offset:1216
    v_mfma_f32_16x16x32_bf16 v[32:35], v[160:163], v[192:195], v[32:35]
    ds_read_b64_tr_b16 v[180:181], v6 offset:96
    ds_read_b64_tr_b16 v[182:183], v6 offset:1248
    v_mfma_f32_16x16x32_bf16 v[68:71], v[164:167], v[192:195], v[68:71]
    ds_read_b64_tr_b16 v[184:185], v6 offset:128
    ds_read_b64_tr_b16 v[186:187], v6 offset:1280
    v_mfma_f32_16x16x32_bf16 v[36:39], v[160:163], v[196:199], v[36:39]
    ds_read_b64_tr_b16 v[188:189], v6 offset:160
    ds_read_b64_tr_b16 v[190:191], v6 offset:1312
    v_mfma_f32_16x16x32_bf16 v[72:75], v[164:167], v[196:199], v[72:75]
    ds_read_b64_tr_b16 v[192:193], v6 offset:192
    v_mfma_f32_16x16x32_bf16 v[40:43], v[160:163], v[200:203], v[40:43]
    ds_read_b64_tr_b16 v[194:195], v6 offset:1344
    ds_read_b64_tr_b16 v[196:197], v6 offset:224
    v_mfma_f32_16x16x32_bf16 v[76:79], v[164:167], v[200:203], v[76:79]
    ds_read_b64_tr_b16 v[198:199], v6 offset:1376
    ds_read_b64_tr_b16 v[200:201], v6 offset:256
    ds_read_b64_tr_b16 v[202:203], v6 offset:1408
    s_add_u32 s31, s31, 1
    s_cmp_lt_u32 s31, 9
    s_cbranch_scc1 k1_loop0
    buffer_load_dword v243, off, s[48:51], 0 sc1
    s_nop 3
    v_mov_b32 v236, s42
    v_mov_b32 v237, s42
    v_pk_mul_f32 v[220:221], v[8:9], v[8:9]
    v_pk_mul_f32 v[222:223], v[10:11], v[10:11]
    v_pk_mul_f32 v[224:225], v[44:45], v[44:45]
    v_pk_mul_f32 v[226:227], v[46:47], v[46:47]
    v_pk_fma_f32 v[220:221], v[220:221], s[40:41], v[236:237]
    v_pk_fma_f32 v[222:223], v[222:223], s[40:41], v[236:237]
    v_pk_fma_f32 v[224:225], v[224:225], s[40:41], v[236:237]
    v_pk_fma_f32 v[226:227], v[226:227], s[40:41], v[236:237]
    v_pk_mul_f32 v[220:221], v[220:221], v[8:9]
    v_pk_mul_f32 v[222:223], v[222:223], v[10:11]
    v_pk_mul_f32 v[224:225], v[224:225], v[44:45]
    v_pk_mul_f32 v[226:227], v[226:227], v[46:47]
    v_exp_f32 v220, v220
    v_exp_f32 v221, v221
    v_exp_f32 v222, v222
    v_exp_f32 v223, v223
    v_exp_f32 v224, v224
    v_exp_f32 v225, v225
    v_exp_f32 v226, v226
    v_exp_f32 v227, v227
    v_pk_add_f32 v[220:221], v[220:221], 1.0 op_sel_hi:[1,0]
    v_pk_add_f32 v[222:223], v[222:223], 1.0 op_sel_hi:[1,0]
    v_pk_add_f32 v[224:225], v[224:225], 1.0 op_sel_hi:[1,0]
    v_pk_add_f32 v[226:227], v[226:227], 1.0 op_sel_hi:[1,0]
    v_rcp_f32 v220, v220
    v_rcp_f32 v221, v221
    v_rcp_f32 v222, v222
    v_rcp_f32 v223, v223
    v_rcp_f32 v224, v224
    v_rcp_f32 v225, v225
    v_rcp_f32 v226, v226
    v_rcp_f32 v227, v227
    v_pk_mul_f32 v[8:9], v[8:9], v[220:221]
    v_pk_mul_f32 v[10:11], v[10:11], v[222:223]
    v_pk_mul_f32 v[44:45], v[44:45], v[224:225]
    v_pk_mul_f32 v[46:47], v[46:47], v[226:227]
    v_mov_b64 v[204:205], v[8:9]
    v_pk_mul_f32 v[212:213], v[8:9], v[8:9]
    v_mov_b64 v[206:207], v[10:11]
    v_pk_mul_f32 v[214:215], v[10:11], v[10:11]
    v_mov_b64 v[208:209], v[44:45]
    v_pk_mul_f32 v[216:217], v[44:45], v[44:45]
    v_mov_b64 v[210:211], v[46:47]
    v_pk_mul_f32 v[218:219], v[46:47], v[46:47]
    v_pk_mul_f32 v[228:229], v[12:13], v[12:13]
    v_pk_mul_f32 v[230:231], v[14:15], v[14:15]
    v_pk_mul_f32 v[232:233], v[48:49], v[48:49]
    v_pk_mul_f32 v[234:235], v[50:51], v[50:51]
    v_pk_fma_f32 v[228:229], v[228:229], s[40:41], v[236:237]
    v_pk_fma_f32 v[230:231], v[230:231], s[40:41], v[236:237]
    v_pk_fma_f32 v[232:233], v[232:233], s[40:41], v[236:237]
    v_pk_fma_f32 v[234:235], v[234:235], s[40:41], v[236:237]
    v_pk_mul_f32 v[228:229], v[228:229], v[12:13]
    v_pk_mul_f32 v[230:231], v[230:231], v[14:15]
    v_pk_mul_f32 v[232:233], v[232:233], v[48:49]
    v_pk_mul_f32 v[234:235], v[234:235], v[50:51]
    v_exp_f32 v228, v228
    v_exp_f32 v229, v229
    v_exp_f32 v230, v230
    v_exp_f32 v231, v231
    v_exp_f32 v232, v232
    v_exp_f32 v233, v233
    v_exp_f32 v234, v234
    v_exp_f32 v235, v235
    v_pk_add_f32 v[228:229], v[228:229], 1.0 op_sel_hi:[1,0]
    v_pk_add_f32 v[230:231], v[230:231], 1.0 op_sel_hi:[1,0]
    v_pk_add_f32 v[232:233], v[232:233], 1.0 op_sel_hi:[1,0]
    v_pk_add_f32 v[234:235], v[234:235], 1.0 op_sel_hi:[1,0]
    v_rcp_f32 v228, v228
    v_rcp_f32 v229, v229
    v_rcp_f32 v230, v230
    v_rcp_f32 v231, v231
    v_rcp_f32 v232, v232
    v_rcp_f32 v233, v233
    v_rcp_f32 v234, v234
    v_rcp_f32 v235, v235
    v_pk_mul_f32 v[12:13], v[12:13], v[228:229]
    v_pk_mul_f32 v[14:15], v[14:15], v[230:231]
    v_pk_mul_f32 v[48:49], v[48:49], v[232:233]
    v_pk_mul_f32 v[50:51], v[50:51], v[234:235]
    v_pk_add_f32 v[204:205], v[204:205], v[12:13]
    v_pk_fma_f32 v[212:213], v[12:13], v[12:13], v[212:213]
    v_pk_add_f32 v[206:207], v[206:207], v[14:15]
    v_pk_fma_f32 v[214:215], v[14:15], v[14:15], v[214:215]
    v_pk_add_f32 v[208:209], v[208:209], v[48:49]
    v_pk_fma_f32 v[216:217], v[48:49], v[48:49], v[216:217]
    v_pk_add_f32 v[210:211], v[210:211], v[50:51]
    v_pk_fma_f32 v[218:219], v[50:51], v[50:51], v[218:219]
    v_pk_mul_f32 v[220:221], v[16:17], v[16:17]
    v_pk_mul_f32 v[222:223], v[18:19], v[18:19]
    v_pk_mul_f32 v[224:225], v[52:53], v[52:53]
    v_pk_mul_f32 v[226:227], v[54:55], v[54:55]
    v_pk_fma_f32 v[220:221], v[220:221], s[40:41], v[236:237]
    v_pk_fma_f32 v[222:223], v[222:223], s[40:41], v[236:237]
    v_pk_fma_f32 v[224:225], v[224:225], s[40:41], v[236:237]
    v_pk_fma_f32 v[226:227], v[226:227], s[40:41], v[236:237]
    v_pk_mul_f32 v[220:221], v[220:221], v[16:17]
    v_pk_mul_f32 v[222:223], v[222:223], v[18:19]
    v_pk_mul_f32 v[224:225], v[224:225], v[52:53]
    v_pk_mul_f32 v[226:227], v[226:227], v[54:55]
    v_exp_f32 v220, v220
    v_exp_f32 v221, v221
    v_exp_f32 v222, v222
    v_exp_f32 v223, v223
    v_exp_f32 v224, v224
    v_exp_f32 v225, v225
    v_exp_f32 v226, v226
    v_exp_f32 v227, v227
    v_pk_add_f32 v[220:221], v[220:221], 1.0 op_sel_hi:[1,0]
    v_pk_add_f32 v[222:223], v[222:223], 1.0 op_sel_hi:[1,0]
    v_pk_add_f32 v[224:225], v[224:225], 1.0 op_sel_hi:[1,0]
    v_pk_add_f32 v[226:227], v[226:227], 1.0 op_sel_hi:[1,0]
    v_rcp_f32 v220, v220
    v_rcp_f32 v221, v221
    v_rcp_f32 v222, v222
    v_rcp_f32 v223, v223
    v_rcp_f32 v224, v224
    v_rcp_f32 v225, v225
    v_rcp_f32 v226, v226
    v_rcp_f32 v227, v227
    v_pk_mul_f32 v[16:17], v[16:17], v[220:221]
    v_pk_mul_f32 v[18:19], v[18:19], v[222:223]
    v_pk_mul_f32 v[52:53], v[52:53], v[224:225]
    v_pk_mul_f32 v[54:55], v[54:55], v[226:227]
    v_pk_add_f32 v[204:205], v[204:205], v[16:17]
    v_pk_fma_f32 v[212:213], v[16:17], v[16:17], v[212:213]
    v_pk_add_f32 v[206:207], v[206:207], v[18:19]
    v_pk_fma_f32 v[214:215], v[18:19], v[18:19], v[214:215]
    v_pk_add_f32 v[208:209], v[208:209], v[52:53]
    v_pk_fma_f32 v[216:217], v[52:53], v[52:53], v[216:217]
    v_pk_add_f32 v[210:211], v[210:211], v[54:55]
    v_pk_fma_f32 v[218:219], v[54:55], v[54:55], v[218:219]
    v_pk_mul_f32 v[228:229], v[20:21], v[20:21]
    v_pk_mul_f32 v[230:231], v[22:23], v[22:23]
    v_pk_mul_f32 v[232:233], v[56:57], v[56:57]
    v_pk_mul_f32 v[234:235], v[58:59], v[58:59]
    v_pk_fma_f32 v[228:229], v[228:229], s[40:41], v[236:237]
    v_pk_fma_f32 v[230:231], v[230:231], s[40:41], v[236:237]
    v_pk_fma_f32 v[232:233], v[232:233], s[40:41], v[236:237]
    v_pk_fma_f32 v[234:235], v[234:235], s[40:41], v[236:237]
    v_pk_mul_f32 v[228:229], v[228:229], v[20:21]
    v_pk_mul_f32 v[230:231], v[230:231], v[22:23]
    v_pk_mul_f32 v[232:233], v[232:233], v[56:57]
    v_pk_mul_f32 v[234:235], v[234:235], v[58:59]
    v_exp_f32 v228, v228
    v_exp_f32 v229, v229
    v_exp_f32 v230, v230
    v_exp_f32 v231, v231
    v_exp_f32 v232, v232
    v_exp_f32 v233, v233
    v_exp_f32 v234, v234
    v_exp_f32 v235, v235
    v_pk_add_f32 v[228:229], v[228:229], 1.0 op_sel_hi:[1,0]
    v_pk_add_f32 v[230:231], v[230:231], 1.0 op_sel_hi:[1,0]
    v_pk_add_f32 v[232:233], v[232:233], 1.0 op_sel_hi:[1,0]
    v_pk_add_f32 v[234:235], v[234:235], 1.0 op_sel_hi:[1,0]
    v_rcp_f32 v228, v228
    v_rcp_f32 v229, v229
    v_rcp_f32 v230, v230
    v_rcp_f32 v231, v231
    v_rcp_f32 v232, v232
    v_rcp_f32 v233, v233
    v_rcp_f32 v234, v234
    v_rcp_f32 v235, v235
    v_pk_mul_f32 v[20:21], v[20:21], v[228:229]
    v_pk_mul_f32 v[22:23], v[22:23], v[230:231]
    v_pk_mul_f32 v[56:57], v[56:57], v[232:233]
    v_pk_mul_f32 v[58:59], v[58:59], v[234:235]
    v_pk_add_f32 v[204:205], v[204:205], v[20:21]
    v_pk_fma_f32 v[212:213], v[20:21], v[20:21], v[212:213]
    v_pk_add_f32 v[206:207], v[206:207], v[22:23]
    v_pk_fma_f32 v[214:215], v[22:23], v[22:23], v[214:215]
    v_pk_add_f32 v[208:209], v[208:209], v[56:57]
    v_pk_fma_f32 v[216:217], v[56:57], v[56:57], v[216:217]
    v_pk_add_f32 v[210:211], v[210:211], v[58:59]
    v_pk_fma_f32 v[218:219], v[58:59], v[58:59], v[218:219]
    v_pk_mul_f32 v[220:221], v[24:25], v[24:25]
    v_pk_mul_f32 v[222:223], v[26:27], v[26:27]
    v_pk_mul_f32 v[224:225], v[60:61], v[60:61]
    v_pk_mul_f32 v[226:227], v[62:63], v[62:63]
    v_pk_fma_f32 v[220:221], v[220:221], s[40:41], v[236:237]
    v_pk_fma_f32 v[222:223], v[222:223], s[40:41], v[236:237]
    v_pk_fma_f32 v[224:225], v[224:225], s[40:41], v[236:237]
    v_pk_fma_f32 v[226:227], v[226:227], s[40:41], v[236:237]
    v_pk_mul_f32 v[220:221], v[220:221], v[24:25]
    v_pk_mul_f32 v[222:223], v[222:223], v[26:27]
    v_pk_mul_f32 v[224:225], v[224:225], v[60:61]
    v_pk_mul_f32 v[226:227], v[226:227], v[62:63]
    v_exp_f32 v220, v220
    v_exp_f32 v221, v221
    v_exp_f32 v222, v222
    v_exp_f32 v223, v223
    v_exp_f32 v224, v224
    v_exp_f32 v225, v225
    v_exp_f32 v226, v226
    v_exp_f32 v227, v227
    v_pk_add_f32 v[220:221], v[220:221], 1.0 op_sel_hi:[1,0]
    v_pk_add_f32 v[222:223], v[222:223], 1.0 op_sel_hi:[1,0]
    v_pk_add_f32 v[224:225], v[224:225], 1.0 op_sel_hi:[1,0]
    v_pk_add_f32 v[226:227], v[226:227], 1.0 op_sel_hi:[1,0]
    v_rcp_f32 v220, v220
    v_rcp_f32 v221, v221
    v_rcp_f32 v222, v222
    v_rcp_f32 v223, v223
    v_rcp_f32 v224, v224
    v_rcp_f32 v225, v225
    v_rcp_f32 v226, v226
    v_rcp_f32 v227, v227
    v_pk_mul_f32 v[24:25], v[24:25], v[220:221]
    v_pk_mul_f32 v[26:27], v[26:27], v[222:223]
    v_pk_mul_f32 v[60:61], v[60:61], v[224:225]
    v_pk_mul_f32 v[62:63], v[62:63], v[226:227]
    v_pk_add_f32 v[204:205], v[204:205], v[24:25]
    v_pk_fma_f32 v[212:213], v[24:25], v[24:25], v[212:213]
    v_pk_add_f32 v[206:207], v[206:207], v[26:27]
    v_pk_fma_f32 v[214:215], v[26:27], v[26:27], v[214:215]
    v_pk_add_f32 v[208:209], v[208:209], v[60:61]
    v_pk_fma_f32 v[216:217], v[60:61], v[60:61], v[216:217]
    v_pk_add_f32 v[210:211], v[210:211], v[62:63]
    v_pk_fma_f32 v[218:219], v[62:63], v[62:63], v[218:219]
    v_pk_mul_f32 v[228:229], v[28:29], v[28:29]
    v_pk_mul_f32 v[230:231], v[30:31], v[30:31]
    v_pk_mul_f32 v[232:233], v[64:65], v[64:65]
    v_pk_mul_f32 v[234:235], v[66:67], v[66:67]
    v_pk_fma_f32 v[228:229], v[228:229], s[40:41], v[236:237]
    v_pk_fma_f32 v[230:231], v[230:231], s[40:41], v[236:237]
    v_pk_fma_f32 v[232:233], v[232:233], s[40:41], v[236:237]
    v_pk_fma_f32 v[234:235], v[234:235], s[40:41], v[236:237]
    v_pk_mul_f32 v[228:229], v[228:229], v[28:29]
    v_pk_mul_f32 v[230:231], v[230:231], v[30:31]
    v_pk_mul_f32 v[232:233], v[232:233], v[64:65]
    v_pk_mul_f32 v[234:235], v[234:235], v[66:67]
    v_exp_f32 v228, v228
    v_exp_f32 v229, v229
    v_exp_f32 v230, v230
    v_exp_f32 v231, v231
    v_exp_f32 v232, v232
    v_exp_f32 v233, v233
    v_exp_f32 v234, v234
    v_exp_f32 v235, v235
    v_pk_add_f32 v[228:229], v[228:229], 1.0 op_sel_hi:[1,0]
    v_pk_add_f32 v[230:231], v[230:231], 1.0 op_sel_hi:[1,0]
    v_pk_add_f32 v[232:233], v[232:233], 1.0 op_sel_hi:[1,0]
    v_pk_add_f32 v[234:235], v[234:235], 1.0 op_sel_hi:[1,0]
    v_rcp_f32 v228, v228
    v_rcp_f32 v229, v229
    v_rcp_f32 v230, v230
    v_rcp_f32 v231, v231
    v_rcp_f32 v232, v232
    v_rcp_f32 v233, v233
    v_rcp_f32 v234, v234
    v_rcp_f32 v235, v235
    v_pk_mul_f32 v[28:29], v[28:29], v[228:229]
    v_pk_mul_f32 v[30:31], v[30:31], v[230:231]
    v_pk_mul_f32 v[64:65], v[64:65], v[232:233]
    v_pk_mul_f32 v[66:67], v[66:67], v[234:235]
    v_pk_add_f32 v[204:205], v[204:205], v[28:29]
    v_pk_fma_f32 v[212:213], v[28:29], v[28:29], v[212:213]
    v_pk_add_f32 v[206:207], v[206:207], v[30:31]
    v_pk_fma_f32 v[214:215], v[30:31], v[30:31], v[214:215]
    v_pk_add_f32 v[208:209], v[208:209], v[64:65]
    v_pk_fma_f32 v[216:217], v[64:65], v[64:65], v[216:217]
    v_pk_add_f32 v[210:211], v[210:211], v[66:67]
    v_pk_fma_f32 v[218:219], v[66:67], v[66:67], v[218:219]
    v_pk_mul_f32 v[220:221], v[32:33], v[32:33]
    v_pk_mul_f32 v[222:223], v[34:35], v[34:35]
    v_pk_mul_f32 v[224:225], v[68:69], v[68:69]
    v_pk_mul_f32 v[226:227], v[70:71], v[70:71]
    v_pk_fma_f32 v[220:221], v[220:221], s[40:41], v[236:237]
    v_pk_fma_f32 v[222:223], v[222:223], s[40:41], v[236:237]
    v_pk_fma_f32 v[224:225], v[224:225], s[40:41], v[236:237]
    v_pk_fma_f32 v[226:227], v[226:227], s[40:41], v[236:237]
    v_pk_mul_f32 v[220:221], v[220:221], v[32:33]
    v_pk_mul_f32 v[222:223], v[222:223], v[34:35]
    v_pk_mul_f32 v[224:225], v[224:225], v[68:69]
    v_pk_mul_f32 v[226:227], v[226:227], v[70:71]
    v_exp_f32 v220, v220
    v_exp_f32 v221, v221
    v_exp_f32 v222, v222
    v_exp_f32 v223, v223
    v_exp_f32 v224, v224
    v_exp_f32 v225, v225
    v_exp_f32 v226, v226
    v_exp_f32 v227, v227
    v_pk_add_f32 v[220:221], v[220:221], 1.0 op_sel_hi:[1,0]
    v_pk_add_f32 v[222:223], v[222:223], 1.0 op_sel_hi:[1,0]
    v_pk_add_f32 v[224:225], v[224:225], 1.0 op_sel_hi:[1,0]
    v_pk_add_f32 v[226:227], v[226:227], 1.0 op_sel_hi:[1,0]
    v_rcp_f32 v220, v220
    v_rcp_f32 v221, v221
    v_rcp_f32 v222, v222
    v_rcp_f32 v223, v223
    v_rcp_f32 v224, v224
    v_rcp_f32 v225, v225
    v_rcp_f32 v226, v226
    v_rcp_f32 v227, v227
    v_pk_mul_f32 v[32:33], v[32:33], v[220:221]
    v_pk_mul_f32 v[34:35], v[34:35], v[222:223]
    v_pk_mul_f32 v[68:69], v[68:69], v[224:225]
    v_pk_mul_f32 v[70:71], v[70:71], v[226:227]
    v_pk_add_f32 v[204:205], v[204:205], v[32:33]
    v_pk_fma_f32 v[212:213], v[32:33], v[32:33], v[212:213]
    v_pk_add_f32 v[206:207], v[206:207], v[34:35]
    v_pk_fma_f32 v[214:215], v[34:35], v[34:35], v[214:215]
    v_pk_add_f32 v[208:209], v[208:209], v[68:69]
    v_pk_fma_f32 v[216:217], v[68:69], v[68:69], v[216:217]
    v_pk_add_f32 v[210:211], v[210:211], v[70:71]
    v_pk_fma_f32 v[218:219], v[70:71], v[70:71], v[218:219]
    v_pk_mul_f32 v[228:229], v[36:37], v[36:37]
    v_pk_mul_f32 v[230:231], v[38:39], v[38:39]
    v_pk_mul_f32 v[232:233], v[72:73], v[72:73]
    v_pk_mul_f32 v[234:235], v[74:75], v[74:75]
    v_pk_fma_f32 v[228:229], v[228:229], s[40:41], v[236:237]
    v_pk_fma_f32 v[230:231], v[230:231], s[40:41], v[236:237]
    v_pk_fma_f32 v[232:233], v[232:233], s[40:41], v[236:237]
    v_pk_fma_f32 v[234:235], v[234:235], s[40:41], v[236:237]
    v_pk_mul_f32 v[228:229], v[228:229], v[36:37]
    v_pk_mul_f32 v[230:231], v[230:231], v[38:39]
    v_pk_mul_f32 v[232:233], v[232:233], v[72:73]
    v_pk_mul_f32 v[234:235], v[234:235], v[74:75]
    v_exp_f32 v228, v228
    v_exp_f32 v229, v229
    v_exp_f32 v230, v230
    v_exp_f32 v231, v231
    v_exp_f32 v232, v232
    v_exp_f32 v233, v233
    v_exp_f32 v234, v234
    v_exp_f32 v235, v235
    v_pk_add_f32 v[228:229], v[228:229], 1.0 op_sel_hi:[1,0]
    v_pk_add_f32 v[230:231], v[230:231], 1.0 op_sel_hi:[1,0]
    v_pk_add_f32 v[232:233], v[232:233], 1.0 op_sel_hi:[1,0]
    v_pk_add_f32 v[234:235], v[234:235], 1.0 op_sel_hi:[1,0]
    v_rcp_f32 v228, v228
    v_rcp_f32 v229, v229
    v_rcp_f32 v230, v230
    v_rcp_f32 v231, v231
    v_rcp_f32 v232, v232
    v_rcp_f32 v233, v233
    v_rcp_f32 v234, v234
    v_rcp_f32 v235, v235
    v_pk_mul_f32 v[36:37], v[36:37], v[228:229]
    v_pk_mul_f32 v[38:39], v[38:39], v[230:231]
    v_pk_mul_f32 v[72:73], v[72:73], v[232:233]
    v_pk_mul_f32 v[74:75], v[74:75], v[234:235]
    v_pk_add_f32 v[204:205], v[204:205], v[36:37]
    v_pk_fma_f32 v[212:213], v[36:37], v[36:37], v[212:213]
    v_pk_add_f32 v[206:207], v[206:207], v[38:39]
    v_pk_fma_f32 v[214:215], v[38:39], v[38:39], v[214:215]
    v_pk_add_f32 v[208:209], v[208:209], v[72:73]
    v_pk_fma_f32 v[216:217], v[72:73], v[72:73], v[216:217]
    v_pk_add_f32 v[210:211], v[210:211], v[74:75]
    v_pk_fma_f32 v[218:219], v[74:75], v[74:75], v[218:219]
    v_pk_mul_f32 v[220:221], v[40:41], v[40:41]
    v_pk_mul_f32 v[222:223], v[42:43], v[42:43]
    v_pk_mul_f32 v[224:225], v[76:77], v[76:77]
    v_pk_mul_f32 v[226:227], v[78:79], v[78:79]
    v_pk_fma_f32 v[220:221], v[220:221], s[40:41], v[236:237]
    v_pk_fma_f32 v[222:223], v[222:223], s[40:41], v[236:237]
    v_pk_fma_f32 v[224:225], v[224:225], s[40:41], v[236:237]
    v_pk_fma_f32 v[226:227], v[226:227], s[40:41], v[236:237]
    v_pk_mul_f32 v[220:221], v[220:221], v[40:41]
    v_pk_mul_f32 v[222:223], v[222:223], v[42:43]
    v_pk_mul_f32 v[224:225], v[224:225], v[76:77]
    v_pk_mul_f32 v[226:227], v[226:227], v[78:79]
    v_exp_f32 v220, v220
    v_exp_f32 v221, v221
    v_exp_f32 v222, v222
    v_exp_f32 v223, v223
    v_exp_f32 v224, v224
    v_exp_f32 v225, v225
    v_exp_f32 v226, v226
    v_exp_f32 v227, v227
    v_pk_add_f32 v[220:221], v[220:221], 1.0 op_sel_hi:[1,0]
    v_pk_add_f32 v[222:223], v[222:223], 1.0 op_sel_hi:[1,0]
    v_pk_add_f32 v[224:225], v[224:225], 1.0 op_sel_hi:[1,0]
    v_pk_add_f32 v[226:227], v[226:227], 1.0 op_sel_hi:[1,0]
    v_rcp_f32 v220, v220
    v_rcp_f32 v221, v221
    v_rcp_f32 v222, v222
    v_rcp_f32 v223, v223
    v_rcp_f32 v224, v224
    v_rcp_f32 v225, v225
    v_rcp_f32 v226, v226
    v_rcp_f32 v227, v227
    v_pk_mul_f32 v[40:41], v[40:41], v[220:221]
    v_pk_mul_f32 v[42:43], v[42:43], v[222:223]
    v_pk_mul_f32 v[76:77], v[76:77], v[224:225]
    v_pk_mul_f32 v[78:79], v[78:79], v[226:227]
    v_pk_add_f32 v[204:205], v[204:205], v[40:41]
    v_pk_fma_f32 v[212:213], v[40:41], v[40:41], v[212:213]
    v_pk_add_f32 v[206:207], v[206:207], v[42:43]
    v_pk_fma_f32 v[214:215], v[42:43], v[42:43], v[214:215]
    v_pk_add_f32 v[208:209], v[208:209], v[76:77]
    v_pk_fma_f32 v[216:217], v[76:77], v[76:77], v[216:217]
    v_pk_add_f32 v[210:211], v[210:211], v[78:79]
    v_pk_fma_f32 v[218:219], v[78:79], v[78:79], v[218:219]
    s_nop 1
    v_add_f32_dpp v204, v204, v204 row_ror:8 row_mask:0xf bank_mask:0x3
    v_add_f32_dpp v205, v205, v205 row_ror:8 row_mask:0xf bank_mask:0x3
    v_add_f32_dpp v206, v206, v206 row_ror:8 row_mask:0xf bank_mask:0x3
    v_add_f32_dpp v207, v207, v207 row_ror:8 row_mask:0xf bank_mask:0x3
    v_add_f32_dpp v208, v208, v208 row_ror:8 row_mask:0xf bank_mask:0x3
    v_add_f32_dpp v209, v209, v209 row_ror:8 row_mask:0xf bank_mask:0x3
    v_add_f32_dpp v210, v210, v210 row_ror:8 row_mask:0xf bank_mask:0x3
    v_add_f32_dpp v211, v211, v211 row_ror:8 row_mask:0xf bank_mask:0x3
    v_add_f32_dpp v204, v212, v212 row_ror:8 row_mask:0xf bank_mask:0xc
    v_add_f32_dpp v205, v213, v213 row_ror:8 row_mask:0xf bank_mask:0xc
    v_add_f32_dpp v206, v214, v214 row_ror:8 row_mask:0xf bank_mask:0xc
    v_add_f32_dpp v207, v215, v215 row_ror:8 row_mask:0xf bank_mask:0xc
    v_add_f32_dpp v208, v216, v216 row_ror:8 row_mask:0xf bank_mask:0xc
    v_add_f32_dpp v209, v217, v217 row_ror:8 row_mask:0xf bank_mask:0xc
    v_add_f32_dpp v210, v218, v218 row_ror:8 row_mask:0xf bank_mask:0xc
    v_add_f32_dpp v211, v219, v219 row_ror:8 row_mask:0xf bank_mask:0xc
    v_add_f32_dpp v212, v204, v204 row_half_mirror row_mask:0xf bank_mask:0x5
    v_add_f32_dpp v213, v205, v205 row_half_mirror row_mask:0xf bank_mask:0x5
    v_add_f32_dpp v214, v206, v206 row_half_mirror row_mask:0xf bank_mask:0x5
    v_add_f32_dpp v215, v207, v207 row_half_mirror row_mask:0xf bank_mask:0x5
    v_add_f32_dpp v212, v208, v208 row_half_mirror row_mask:0xf bank_mask:0xa
    v_add_f32_dpp v213, v209, v209 row_half_mirror row_mask:0xf bank_mask:0xa
    v_add_f32_dpp v214, v210, v210 row_half_mirror row_mask:0xf bank_mask:0xa
    v_add_f32_dpp v215, v211, v211 row_half_mirror row_mask:0xf bank_mask:0xa
    s_nop 1
    v_add_f32_dpp v212, v212, v212 quad_perm:[1,0,3,2] row_mask:0xf bank_mask:0xf
    v_add_f32_dpp v213, v213, v213 quad_perm:[1,0,3,2] row_mask:0xf bank_mask:0xf
    v_add_f32_dpp v214, v214, v214 quad_perm:[1,0,3,2] row_mask:0xf bank_mask:0xf
    v_add_f32_dpp v215, v215, v215 quad_perm:[1,0,3,2] row_mask:0xf bank_mask:0xf
    s_nop 0
    v_add_f32_dpp v212, v212, v212 quad_perm:[2,3,0,1] row_mask:0xf bank_mask:0xf
    v_add_f32_dpp v213, v213, v213 quad_perm:[2,3,0,1] row_mask:0xf bank_mask:0xf
    v_add_f32_dpp v214, v214, v214 quad_perm:[2,3,0,1] row_mask:0xf bank_mask:0xf
    v_add_f32_dpp v215, v215, v215 quad_perm:[2,3,0,1] row_mask:0xf bank_mask:0xf
    v_and_b32 v248, 3, v1
    v_cmp_eq_u32 vcc, 1, v248
    v_cmp_eq_u32 s[44:45], 2, v248
    v_cmp_eq_u32 s[46:47], 3, v248
    s_nop 1
    v_cndmask_b32 v250, v212, v213, vcc
    v_cndmask_b32 v250, v250, v214, s[44:45]
    v_cndmask_b32 v250, v250, v215, s[46:47]
    s_mov_b32 s73, 0
    s_branch non_c
non_a:
    s_sleep 4
    buffer_load_dword v243, off, s[48:51], 0 sc1
non_c:
    s_waitcnt vmcnt(0)
    v_readfirstlane_b32 s72, v243
    s_add_u32 s73, s73, 1
    s_nop 3
    s_cmp_lg_u32 s72, 0
    s_cbranch_scc1 nok_a
    s_cmp_lt_u32 s73, 262144
    s_cbranch_scc1 non_a
nok_a:
    s_add_u32 s32, s18, 0x3000000
    s_addc_u32 s33, s19, 0
    s_mov_b32 s34, 0x80000
    s_mov_b32 s35, 0x20000
    v_mov_b32 v251, s72
    v_lshlrev_b32 v244, 3, v1
    s_lshl_b32 s36, s22, 2
    s_add_u32 s36, s36, s27
    s_lshl_b32 s36, s36, 13
    s_lshl_b32 s37, s23, 9
    s_add_u32 s37, s37, s36
    s_add_u32 s38, s36, 4096
    buffer_store_dwordx2 v[250:251], v244, s[32:35], s37 offen sc1
    s_mov_b32 s31, 0
    s_mov_b32 s25, 3
k1_loop1:
    s_waitcnt lgkmcnt(12)
    v_mfma_f32_16x16x32_bf16 v[80:83], v[168:171], v[152:155], v[80:83]
    ds_read_b128 v[160:163], v5 offset:0
    v_mfma_f32_16x16x32_bf16 v[116:119], v[168:171], v[156:159], v[116:119]
    ds_read_b128 v[164:167], v5 offset:512
    v_mfma_f32_16x16x32_bf16 v[84:87], v[172:175], v[152:155], v[84:87]
    ds_read_b64_tr_b16 v[168:169], v6 offset:9728
    v_mfma_f32_16x16x32_bf16 v[120:123], v[172:175], v[156:159], v[120:123]
    ds_read_b64_tr_b16 v[170:171], v6 offset:10880
    v_mfma_f32_16x16x32_bf16 v[88:91], v[176:179], v[152:155], v[88:91]
    ds_read_b64_tr_b16 v[172:173], v6 offset:9760
    v_mfma_f32_16x16x32_bf16 v[124:127], v[176:179], v[156:159], v[124:127]
    ds_read_b64_tr_b16 v[174:175], v6 offset:10912
    s_waitcnt lgkmcnt(12)
    v_mfma_f32_16x16x32_bf16 v[92:95], v[180:183], v[152:155], v[92:95]
    ds_read_b64_tr_b16 v[176:177], v6 offset:9792
    v_mfma_f32_16x16x32_bf16 v[128:131], v[180:183], v[156:159], v[128:131]
    ds_read_b64_tr_b16 v[178:179], v6 offset:10944
    v_mfma_f32_16x16x32_bf16 v[96:99], v[184:187], v[152:155], v[96:99]
    ds_read_b64_tr_b16 v[180:181], v6 offset:9824
    v_mfma_f32_16x16x32_bf16 v[132:135], v[184:187], v[156:159], v[132:135]
    ds_read_b64_tr_b16 v[182:183], v6 offset:10976
    v_mfma_f32_16x16x32_bf16 v[100:103], v[188:191], v[152:155], v[100:103]
    ds_read_b64_tr_b16 v[184:185], v6 offset:9856
    v_mfma_f32_16x16x32_bf16 v[136:139], v[188:191], v[156:159], v[136:139]
    ds_read_b64_tr_b16 v[186:187], v6 offset:11008
    s_waitcnt lgkmcnt(12)
    v_mfma_f32_16x16x32_bf16 v[104:107], v[192:195], v[152:155], v[104:107]
    ds_read_b64_tr_b16 v[188:189], v6 offset:9888
    v_mfma_f32_16x16x32_bf16 v[140:143], v[192:195], v[156:159], v[140:143]
    ds_read_b64_tr_b16 v[190:191], v6 offset:11040
    v_mfma_f32_16x16x32_bf16 v[108:111], v[196:199], v[152:155], v[108:111]
    ds_read_b64_tr_b16 v[192:193], v6 offset:9920
    v_mfma_f32_16x16x32_bf16 v[144:147], v[196:199], v[156:159], v[144:147]
    ds_read_b64_tr_b16 v[194:195], v6 offset:11072
    v_mfma_f32_16x16x32_bf16 v[112:115], v[200:203], v[152:155], v[112:115]
    ds_read_b64_tr_b16 v[196:197], v6 offset:9952
    v_mfma_f32_16x16x32_bf16 v[148:151], v[200:203], v[156:159], v[148:151]
    ds_read_b64_tr_b16 v[198:199], v6 offset:11104
    s_waitcnt lgkmcnt(10)
    v_mfma_f32_16x16x32_bf16 v[80:83], v[168:171], v[160:163], v[80:83]
    ds_read_b64_tr_b16 v[200:201], v6 offset:9984
    v_mfma_f32_16x16x32_bf16 v[116:119], v[168:171], v[164:167], v[116:119]
    ds_read_b64_tr_b16 v[202:203], v6 offset:11136
    v_mfma_f32_16x16x32_bf16 v[84:87], v[172:175], v[160:163], v[84:87]
    s_add_u32 s30, s30, 36864
    s_cmp_eq_u32 s30, 147456
    s_cselect_b32 s30, 0, s30
    s_cselect_b32 s29, -110592, s43
    v_add_u32 v4, s29, v4
    v_mfma_f32_16x16x32_bf16 v[120:123], v[172:175], v[164:167], v[120:123]
    v_add_u32 v5, s29, v5
    v_mfma_f32_16x16x32_bf16 v[88:91], v[176:179], v[160:163], v[88:91]
    v_add_u32 v6, s29, v6
    v_mfma_f32_16x16x32_bf16 v[124:127], v[176:179], v[164:167], v[124:127]
    s_waitcnt lgkmcnt(6)
    v_mfma_f32_16x16x32_bf16 v[92:95], v[180:183], v[160:163], v[92:95]
    v_mfma_f32_16x16x32_bf16 v[128:131], v[180:183], v[164:167], v[128:131]
    s_waitcnt lgkmcnt(0)
    s_barrier
    v_mfma_f32_16x16x32_bf16 v[96:99], v[184:187], v[160:163], v[96:99]
    ds_read_b64_tr_b16 v[168:169], v6 offset:0
    ds_read_b64_tr_b16 v[170:171], v6 offset:1152
    v_mfma_f32_16x16x32_bf16 v[132:135], v[184:187], v[164:167], v[132:135]
    ds_read_b128 v[152:155], v4 offset:0
    ds_read_b128 v[156:159], v4 offset:512
    v_mfma_f32_16x16x32_bf16 v[100:103], v[188:191], v[160:163], v[100:103]
    ds_read_b64_tr_b16 v[172:173], v6 offset:32
    ds_read_b64_tr_b16 v[174:175], v6 offset:1184
    v_mfma_f32_16x16x32_bf16 v[136:139], v[188:191], v[164:167], v[136:139]
    ds_read_b64_tr_b16 v[176:177], v6 offset:64
    ds_read_b64_tr_b16 v[178:179], v6 offset:1216
    v_mfma_f32_16x16x32_bf16 v[104:107], v[192:195], v[160:163], v[104:107]
    ds_read_b64_tr_b16 v[180:181], v6 offset:96
    ds_read_b64_tr_b16 v[182:183], v6 offset:1248
    v_mfma_f32_16x16x32_bf16 v[140:143], v[192:195], v[164:167], v[140:143]
    ds_read_b64_tr_b16 v[184:185], v6 offset:128
    ds_read_b64_tr_b16 v[186:187], v6 offset:1280
    v_mfma_f32_16x16x32_bf16 v[108:111], v[196:199], v[160:163], v[108:111]
    ds_read_b64_tr_b16 v[188:189], v6 offset:160
    ds_read_b64_tr_b16 v[190:191], v6 offset:1312
    v_mfma_f32_16x16x32_bf16 v[144:147], v[196:199], v[164:167], v[144:147]
    ds_read_b64_tr_b16 v[192:193], v6 offset:192
    v_mfma_f32_16x16x32_bf16 v[112:115], v[200:203], v[160:163], v[112:115]
    ds_read_b64_tr_b16 v[194:195], v6 offset:1344
    ds_read_b64_tr_b16 v[196:197], v6 offset:224
    v_mfma_f32_16x16x32_bf16 v[148:151], v[200:203], v[164:167], v[148:151]
    ds_read_b64_tr_b16 v[198:199], v6 offset:1376
    ds_read_b64_tr_b16 v[200:201], v6 offset:256
    ds_read_b64_tr_b16 v[202:203], v6 offset:1408
    s_add_u32 s31, s31, 1
    s_cmp_lg_u32 s31, s25
    s_cbranch_scc1 k1_loop1
    s_cmp_eq_u32 s31, 4
    s_cbranch_scc1 brk2
    s_cmp_eq_u32 s31, 6
    s_cbranch_scc1 brk3
    s_cmp_eq_u32 s31, 9
    s_cbranch_scc1 brk9
    buffer_load_dwordx2 v[204:205], v244, s[32:35], s36 offen offset:0 sc1
    buffer_load_dwordx2 v[206:207], v244, s[32:35], s36 offen offset:512 sc1
    buffer_load_dwordx2 v[208:209], v244, s[32:35], s36 offen offset:1024 sc1
    buffer_load_dwordx2 v[210:211], v244, s[32:35], s36 offen offset:1536 sc1
    buffer_load_dwordx2 v[212:213], v244, s[32:35], s36 offen offset:2048 sc1
    buffer_load_dwordx2 v[214:215], v244, s[32:35], s36 offen offset:2560 sc1
    buffer_load_dwordx2 v[216:217], v244, s[32:35], s36 offen offset:3072 sc1
    buffer_load_dwordx2 v[218:219], v244, s[32:35], s36 offen offset:3584 sc1
    buffer_load_dwordx2 v[220:221], v244, s[32:35], s38 offen offset:0 sc1
    buffer_load_dwordx2 v[222:223], v244, s[32:35], s38 offen offset:512 sc1
    buffer_load_dwordx2 v[224:225], v244, s[32:35], s38 offen offset:1024 sc1
    buffer_load_dwordx2 v[226:227], v244, s[32:35], s38 offen offset:1536 sc1
    buffer_load_dwordx2 v[228:229], v244, s[32:35], s38 offen offset:2048 sc1
    buffer_load_dwordx2 v[230:231], v244, s[32:35], s38 offen offset:2560 sc1
    buffer_load_dwordx2 v[232:233], v244, s[32:35], s38 offen offset:3072 sc1
    buffer_load_dwordx2 v[234:235], v244, s[32:35], s38 offen offset:3584 sc1
    s_mov_b32 s25, 4
    s_branch k1_loop1
brk2:
    s_mov_b32 s73, 0
    s_branch st_chk
st_again:
    s_sleep 4
    buffer_load_dwordx2 v[204:205], v244, s[32:35], s36 offen offset:0 sc1
    buffer_load_dwordx2 v[206:207], v244, s[32:35], s36 offen offset:512 sc1
    buffer_load_dwordx2 v[208:209], v244, s[32:35], s36 offen offset:1024 sc1
    buffer_load_dwordx2 v[210:211], v244, s[32:35], s36 offen offset:1536 sc1
    buffer_load_dwordx2 v[212:213], v244, s[32:35], s36 offen offset:2048 sc1
    buffer_load_dwordx2 v[214:215], v244, s[32:35], s36 offen offset:2560 sc1
    buffer_load_dwordx2 v[216:217], v244, s[32:35], s36 offen offset:3072 sc1
    buffer_load_dwordx2 v[218:219], v244, s[32:35], s36 offen offset:3584 sc1
    buffer_load_dwordx2 v[220:221], v244, s[32:35], s38 offen offset:0 sc1
    buffer_load_dwordx2 v[222:223], v244, s[32:35], s38 offen offset:512 sc1
    buffer_load_dwordx2 v[224:225], v244, s[32:35], s38 offen offset:1024 sc1
    buffer_load_dwordx2 v[226:227], v244, s[32:35], s38 offen offset:1536 sc1
    buffer_load_dwordx2 v[228:229], v244, s[32:35], s38 offen offset:2048 sc1
    buffer_load_dwordx2 v[230:231], v244, s[32:35], s38 offen offset:2560 sc1
    buffer_load_dwordx2 v[232:233], v244, s[32:35], s38 offen offset:3072 sc1
    buffer_load_dwordx2 v[234:235], v244, s[32:35], s38 offen offset:3584 sc1
st_chk:
    s_waitcnt vmcnt(0)
    v_min_u32 v248, v205, v207
    v_max_u32 v249, v205, v207
    v_min3_u32 v248, v248, v209, v211
    v_max3_u32 v249, v249, v209, v211
    v_min3_u32 v248, v248, v213, v215
    v_max3_u32 v249, v249, v213, v215
    v_min3_u32 v248, v248, v217, v219
    v_max3_u32 v249, v249, v217, v219
    v_min3_u32 v248, v248, v221, v223
    v_max3_u32 v249, v249, v221, v223
    v_min3_u32 v248, v248, v225, v227
    v_max3_u32 v249, v249, v225, v227
    v_min3_u32 v248, v248, v229, v231
    v_max3_u32 v249, v249, v229, v231
    v_min3_u32 v248, v248, v233, v235
    v_max3_u32 v249, v249, v233, v235
    v_cmp_ne_u32 vcc, s72, v248
    v_cmp_ne_u32 s[44:45], s72, v249
    s_add_u32 s73, s73, 1
    s_nop 3
    s_or_b64 vcc, vcc, s[44:45]
    s_cbranch_scc0 st_ok
    s_cmp_lt_u32 s73, 262144
    s_cbranch_scc1 st_again
st_ok:
    v_add_f32 v204, v204, v206
    v_add_f32 v208, v208, v210
    v_add_f32 v212, v212, v214
    v_add_f32 v216, v216, v218
    v_add_f32 v220, v220, v222
    v_add_f32 v224, v224, v226
    v_add_f32 v228, v228, v230
    v_add_f32 v232, v232, v234
    v_add_f32 v204, v204, v208
    v_add_f32 v212, v212, v216
    v_add_f32 v220, v220, v224
    v_add_f32 v228, v228, v232
    v_add_f32 v204, v204, v212
    v_add_f32 v220, v220, v228
    v_add_f32 v248, v204, v220
    s_mov_b32 s44, 0x39e38e39
    s_mov_b32 s45, 0x3727c5ac
    v_mul_f32 v248, s44, v248
    s_nop 1
    v_mov_b32_dpp v249, v248 row_ror:8 row_mask:0xf bank_mask:0xf
    v_fma_f32 v249, -v248, v248, v249
    v_max_f32 v249, 0, v249
    v_add_f32 v249, s45, v249
    v_rsq_f32 v249, v249
    s_nop 0
    v_mul_f32 v248, v248, v249
    s_nop 1
    v_mov_b32_dpp v212, v249 row_newbcast:0 row_mask:0xf bank_mask:0xf
    v_mov_b32_dpp v204, v248 row_newbcast:0 row_mask:0xf bank_mask:0xf
    v_mov_b32_dpp v213, v249 row_newbcast:1 row_mask:0xf bank_mask:0xf
    v_mov_b32_dpp v205, v248 row_newbcast:1 row_mask:0xf bank_mask:0xf
    v_mov_b32_dpp v214, v249 row_newbcast:2 row_mask:0xf bank_mask:0xf
    v_mov_b32_dpp v206, v248 row_newbcast:2 row_mask:0xf bank_mask:0xf
    v_mov_b32_dpp v215, v249 row_newbcast:3 row_mask:0xf bank_mask:0xf
    v_mov_b32_dpp v207, v248 row_newbcast:3 row_mask:0xf bank_mask:0xf
    v_mov_b32_dpp v216, v249 row_newbcast:4 row_mask:0xf bank_mask:0xf
    v_mov_b32_dpp v208, v248 row_newbcast:4 row_mask:0xf bank_mask:0xf
    v_mov_b32_dpp v217, v249 row_newbcast:5 row_mask:0xf bank_mask:0xf
    v_mov_b32_dpp v209, v248 row_newbcast:5 row_mask:0xf bank_mask:0xf
    v_mov_b32_dpp v218, v249 row_newbcast:6 row_mask:0xf bank_mask:0xf
    v_mov_b32_dpp v210, v248 row_newbcast:6 row_mask:0xf bank_mask:0xf
    v_mov_b32_dpp v219, v249 row_newbcast:7 row_mask:0xf bank_mask:0xf
    v_mov_b32_dpp v211, v248 row_newbcast:7 row_mask:0xf bank_mask:0xf
    s_add_u32 s32, s18, 0x1000000
    s_addc_u32 s33, s19, 0
    s_mov_b32 s34, 0x900000
    s_mov_b32 s35, 0x20000
    s_lshl_b32 s36, s23, 6
    s_lshl_b32 s37, s22, 2
    s_add_u32 s36, s36, s37
    s_add_u32 s36, s36, s27
    s_lshl_b32 s38, s36, 4
    s_mul_i32 s36, s36, 9216
    v_pk_fma_f32 v[8:9], v[8:9], v[212:213], v[204:205] neg_lo:[0,0,1] neg_hi:[0,0,1]
    v_pk_fma_f32 v[10:11], v[10:11], v[214:215], v[206:207] neg_lo:[0,0,1] neg_hi:[0,0,1]
    v_pk_fma_f32 v[44:45], v[44:45], v[216:217], v[208:209] neg_lo:[0,0,1] neg_hi:[0,0,1]
    v_pk_fma_f32 v[46:47], v[46:47], v[218:219], v[210:211] neg_lo:[0,0,1] neg_hi:[0,0,1]
    v_cvt_pk_bf16_f32 v220, v8, v9
    v_cvt_pk_bf16_f32 v221, v10, v11
    v_cvt_pk_bf16_f32 v222, v44, v45
    v_cvt_pk_bf16_f32 v223, v46, v47
    buffer_store_dwordx4 v[220:223], v7, s[32:35], s36 offen offset:0 sc1
    v_pk_fma_f32 v[12:13], v[12:13], v[212:213], v[204:205] neg_lo:[0,0,1] neg_hi:[0,0,1]
    v_pk_fma_f32 v[14:15], v[14:15], v[214:215], v[206:207] neg_lo:[0,0,1] neg_hi:[0,0,1]
    v_pk_fma_f32 v[48:49], v[48:49], v[216:217], v[208:209] neg_lo:[0,0,1] neg_hi:[0,0,1]
    v_pk_fma_f32 v[50:51], v[50:51], v[218:219], v[210:211] neg_lo:[0,0,1] neg_hi:[0,0,1]
    v_cvt_pk_bf16_f32 v224, v12, v13
    v_cvt_pk_bf16_f32 v225, v14, v15
    v_cvt_pk_bf16_f32 v226, v48, v49
    v_cvt_pk_bf16_f32 v227, v50, v51
    buffer_store_dwordx4 v[224:227], v7, s[32:35], s36 offen offset:1024 sc1
    v_pk_fma_f32 v[16:17], v[16:17], v[212:213], v[204:205] neg_lo:[0,0,1] neg_hi:[0,0,1]
    v_pk_fma_f32 v[18:19], v[18:19], v[214:215], v[206:207] neg_lo:[0,0,1] neg_hi:[0,0,1]
    v_pk_fma_f32 v[52:53], v[52:53], v[216:217], v[208:209] neg_lo:[0,0,1] neg_hi:[0,0,1]
    v_pk_fma_f32 v[54:55], v[54:55], v[218:219], v[210:211] neg_lo:[0,0,1] neg_hi:[0,0,1]
    v_cvt_pk_bf16_f32 v228, v16, v17
    v_cvt_pk_bf16_f32 v229, v18, v19
    v_cvt_pk_bf16_f32 v230, v52, v53
    v_cvt_pk_bf16_f32 v231, v54, v55
    buffer_store_dwordx4 v[228:231], v7, s[32:35], s36 offen offset:2048 sc1
    v_pk_fma_f32 v[20:21], v[20:21], v[212:213], v[204:205] neg_lo:[0,0,1] neg_hi:[0,0,1]
    v_pk_fma_f32 v[22:23], v[22:23], v[214:215], v[206:207] neg_lo:[0,0,1] neg_hi:[0,0,1]
    v_pk_fma_f32 v[56:57], v[56:57], v[216:217], v[208:209] neg_lo:[0,0,1] neg_hi:[0,0,1]
    v_pk_fma_f32 v[58:59], v[58:59], v[218:219], v[210:211] neg_lo:[0,0,1] neg_hi:[0,0,1]
    v_cvt_pk_bf16_f32 v232, v20, v21
    v_cvt_pk_bf16_f32 v233, v22, v23
    v_cvt_pk_bf16_f32 v234, v56, v57
    v_cvt_pk_bf16_f32 v235, v58, v59
    buffer_store_dwordx4 v[232:235], v7, s[32:35], s36 offen offset:3072 sc1
    s_add_u32 s36, s36, 4096
    v_pk_fma_f32 v[24:25], v[24:25], v[212:213], v[204:205] neg_lo:[0,0,1] neg_hi:[0,0,1]
    v_pk_fma_f32 v[26:27], v[26:27], v[214:215], v[206:207] neg_lo:[0,0,1] neg_hi:[0,0,1]
    v_pk_fma_f32 v[60:61], v[60:61], v[216:217], v[208:209] neg_lo:[0,0,1] neg_hi:[0,0,1]
    v_pk_fma_f32 v[62:63], v[62:63], v[218:219], v[210:211] neg_lo:[0,0,1] neg_hi:[0,0,1]
    v_cvt_pk_bf16_f32 v220, v24, v25
    v_cvt_pk_bf16_f32 v221, v26, v27
    v_cvt_pk_bf16_f32 v222, v60, v61
    v_cvt_pk_bf16_f32 v223, v62, v63
    buffer_store_dwordx4 v[220:223], v7, s[32:35], s36 offen offset:0 sc1
    v_pk_fma_f32 v[28:29], v[28:29], v[212:213], v[204:205] neg_lo:[0,0,1] neg_hi:[0,0,1]
    v_pk_fma_f32 v[30:31], v[30:31], v[214:215], v[206:207] neg_lo:[0,0,1] neg_hi:[0,0,1]
    v_pk_fma_f32 v[64:65], v[64:65], v[216:217], v[208:209] neg_lo:[0,0,1] neg_hi:[0,0,1]
    v_pk_fma_f32 v[66:67], v[66:67], v[218:219], v[210:211] neg_lo:[0,0,1] neg_hi:[0,0,1]
    v_cvt_pk_bf16_f32 v224, v28, v29
    v_cvt_pk_bf16_f32 v225, v30, v31
    v_cvt_pk_bf16_f32 v226, v64, v65
    v_cvt_pk_bf16_f32 v227, v66, v67
    buffer_store_dwordx4 v[224:227], v7, s[32:35], s36 offen offset:1024 sc1
    v_pk_fma_f32 v[32:33], v[32:33], v[212:213], v[204:205] neg_lo:[0,0,1] neg_hi:[0,0,1]
    v_pk_fma_f32 v[34:35], v[34:35], v[214:215], v[206:207] neg_lo:[0,0,1] neg_hi:[0,0,1]
    v_pk_fma_f32 v[68:69], v[68:69], v[216:217], v[208:209] neg_lo:[0,0,1] neg_hi:[0,0,1]
    v_pk_fma_f32 v[70:71], v[70:71], v[218:219], v[210:211] neg_lo:[0,0,1] neg_hi:[0,0,1]
    v_cvt_pk_bf16_f32 v228, v32, v33
    v_cvt_pk_bf16_f32 v229, v34, v35
    v_cvt_pk_bf16_f32 v230, v68, v69
    v_cvt_pk_bf16_f32 v231, v70, v71
    buffer_store_dwordx4 v[228:231], v7, s[32:35], s36 offen offset:2048 sc1
    v_pk_fma_f32 v[36:37], v[36:37], v[212:213], v[204:205] neg_lo:[0,0,1] neg_hi:[0,0,1]
    v_pk_fma_f32 v[38:39], v[38:39], v[214:215], v[206:207] neg_lo:[0,0,1] neg_hi:[0,0,1]
    v_pk_fma_f32 v[72:73], v[72:73], v[216:217], v[208:209] neg_lo:[0,0,1] neg_hi:[0,0,1]
    v_pk_fma_f32 v[74:75], v[74:75], v[218:219], v[210:211] neg_lo:[0,0,1] neg_hi:[0,0,1]
    v_cvt_pk_bf16_f32 v232, v36, v37
    v_cvt_pk_bf16_f32 v233, v38, v39
    v_cvt_pk_bf16_f32 v234, v72, v73
    v_cvt_pk_bf16_f32 v235, v74, v75
    buffer_store_dwordx4 v[232:235], v7, s[32:35], s36 offen offset:3072 sc1
    s_add_u32 s36, s36, 4096
    v_pk_fma_f32 v[40:41], v[40:41], v[212:213], v[204:205] neg_lo:[0,0,1] neg_hi:[0,0,1]
    v_pk_fma_f32 v[42:43], v[42:43], v[214:215], v[206:207] neg_lo:[0,0,1] neg_hi:[0,0,1]
    v_pk_fma_f32 v[76:77], v[76:77], v[216:217], v[208:209] neg_lo:[0,0,1] neg_hi:[0,0,1]
    v_pk_fma_f32 v[78:79], v[78:79], v[218:219], v[210:211] neg_lo:[0,0,1] neg_hi:[0,0,1]
    v_cvt_pk_bf16_f32 v220, v40, v41
    v_cvt_pk_bf16_f32 v221, v42, v43
    v_cvt_pk_bf16_f32 v222, v76, v77
    v_cvt_pk_bf16_f32 v223, v78, v79
    buffer_store_dwordx4 v[220:223], v7, s[32:35], s36 offen offset:0 sc1
    s_add_u32 s64, s18, 0x3100000
    s_addc_u32 s65, s19, 0
    s_mov_b32 s66, 0x40000
    s_mov_b32 s67, 0x20000
    v_mov_b32 v243, s72
    s_mov_b32 s25, 6
    s_branch k1_loop1
brk3:
    s_waitcnt vmcnt(0)
    s_mov_b64 exec, 1
    buffer_store_dword v243, off, s[64:67], s38 sc1
    s_mov_b64 exec, -1
    s_mov_b32 s25, 9
    s_branch k1_loop1
brk9:
    v_lshlrev_b32 v246, 16, v246
    v_lshlrev_b32 v248, 16, v247
    v_mov_b32 v247, v246
    v_mov_b32 v249, v248
    v_mov_b64 v[8:9], v[246:247]
    v_mov_b64 v[10:11], v[246:247]
    v_mov_b64 v[12:13], v[246:247]
    v_mov_b64 v[14:15], v[246:247]
    v_mov_b64 v[16:17], v[246:247]
    v_mov_b64 v[18:19], v[246:247]
    v_mov_b64 v[20:21], v[246:247]
    v_mov_b64 v[22:23], v[246:247]
    v_mov_b64 v[24:25], v[246:247]
    v_mov_b64 v[26:27], v[246:247]
    v_mov_b64 v[28:29], v[246:247]
    v_mov_b64 v[30:31], v[246:247]
    v_mov_b64 v[32:33], v[246:247]
    v_mov_b64 v[34:35], v[246:247]
    v_mov_b64 v[36:37], v[246:247]
    v_mov_b64 v[38:39], v[246:247]
    v_mov_b64 v[40:41], v[246:247]
    v_mov_b64 v[42:43], v[246:247]
    v_mov_b64 v[44:45], v[248:249]
    v_mov_b64 v[46:47], v[248:249]
    v_mov_b64 v[48:49], v[248:249]
    v_mov_b64 v[50:51], v[248:249]
    v_mov_b64 v[52:53], v[248:249]
    v_mov_b64 v[54:55], v[248:249]
    v_mov_b64 v[56:57], v[248:249]
    v_mov_b64 v[58:59], v[248:249]
    v_mov_b64 v[60:61], v[248:249]
    v_mov_b64 v[62:63], v[248:249]
    v_mov_b64 v[64:65], v[248:249]
    v_mov_b64 v[66:67], v[248:249]
    v_mov_b64 v[68:69], v[248:249]
    v_mov_b64 v[70:71], v[248:249]
    v_mov_b64 v[72:73], v[248:249]
    v_mov_b64 v[74:75], v[248:249]
    v_mov_b64 v[76:77], v[248:249]
    v_mov_b64 v[78:79], v[248:249]
    s_waitcnt lgkmcnt(0)
    v_mov_b32 v244, s42
    v_mov_b32 v245, s42
    v_pk_mul_f32 v[152:153], v[80:81], v[80:81]
    v_pk_mul_f32 v[154:155], v[82:83], v[82:83]
    v_pk_mul_f32 v[156:157], v[116:117], v[116:117]
    v_pk_mul_f32 v[158:159], v[118:119], v[118:119]
    v_pk_fma_f32 v[152:153], v[152:153], s[40:41], v[244:245]
    v_pk_fma_f32 v[154:155], v[154:155], s[40:41], v[244:245]
    v_pk_fma_f32 v[156:157], v[156:157], s[40:41], v[244:245]
    v_pk_fma_f32 v[158:159], v[158:159], s[40:41], v[244:245]
    v_pk_mul_f32 v[152:153], v[152:153], v[80:81]
    v_pk_mul_f32 v[154:155], v[154:155], v[82:83]
    v_pk_mul_f32 v[156:157], v[156:157], v[116:117]
    v_pk_mul_f32 v[158:159], v[158:159], v[118:119]
    v_exp_f32 v152, v152
    v_exp_f32 v153, v153
    v_exp_f32 v154, v154
    v_exp_f32 v155, v155
    v_exp_f32 v156, v156
    v_exp_f32 v157, v157
    v_exp_f32 v158, v158
    v_exp_f32 v159, v159
    v_pk_add_f32 v[152:153], v[152:153], 1.0 op_sel_hi:[1,0]
    v_pk_add_f32 v[154:155], v[154:155], 1.0 op_sel_hi:[1,0]
    v_pk_add_f32 v[156:157], v[156:157], 1.0 op_sel_hi:[1,0]
    v_pk_add_f32 v[158:159], v[158:159], 1.0 op_sel_hi:[1,0]
    v_rcp_f32 v152, v152
    v_rcp_f32 v153, v153
    v_rcp_f32 v154, v154
    v_rcp_f32 v155, v155
    v_rcp_f32 v156, v156
    v_rcp_f32 v157, v157
    v_rcp_f32 v158, v158
    v_rcp_f32 v159, v159
    v_pk_mul_f32 v[168:169], v[80:81], v[152:153]
    v_pk_mul_f32 v[170:171], v[82:83], v[154:155]
    v_pk_mul_f32 v[204:205], v[116:117], v[156:157]
    v_pk_mul_f32 v[206:207], v[118:119], v[158:159]
    v_pk_mul_f32 v[152:153], v[84:85], v[84:85]
    v_pk_mul_f32 v[154:155], v[86:87], v[86:87]
    v_pk_mul_f32 v[156:157], v[120:121], v[120:121]
    v_pk_mul_f32 v[158:159], v[122:123], v[122:123]
    v_pk_fma_f32 v[152:153], v[152:153], s[40:41], v[244:245]
    v_pk_fma_f32 v[154:155], v[154:155], s[40:41], v[244:245]
    v_pk_fma_f32 v[156:157], v[156:157], s[40:41], v[244:245]
    v_pk_fma_f32 v[158:159], v[158:159], s[40:41], v[244:245]
    v_pk_mul_f32 v[152:153], v[152:153], v[84:85]
    v_pk_mul_f32 v[154:155], v[154:155], v[86:87]
    v_pk_mul_f32 v[156:157], v[156:157], v[120:121]
    v_pk_mul_f32 v[158:159], v[158:159], v[122:123]
    v_exp_f32 v152, v152
    v_exp_f32 v153, v153
    v_exp_f32 v154, v154
    v_exp_f32 v155, v155
    v_exp_f32 v156, v156
    v_exp_f32 v157, v157
    v_exp_f32 v158, v158
    v_exp_f32 v159, v159
    v_pk_add_f32 v[152:153], v[152:153], 1.0 op_sel_hi:[1,0]
    v_pk_add_f32 v[154:155], v[154:155], 1.0 op_sel_hi:[1,0]
    v_pk_add_f32 v[156:157], v[156:157], 1.0 op_sel_hi:[1,0]
    v_pk_add_f32 v[158:159], v[158:159], 1.0 op_sel_hi:[1,0]
    v_rcp_f32 v152, v152
    v_rcp_f32 v153, v153
    v_rcp_f32 v154, v154
    v_rcp_f32 v155, v155
    v_rcp_f32 v156, v156
    v_rcp_f32 v157, v157
    v_rcp_f32 v158, v158
    v_rcp_f32 v159, v159
    v_pk_mul_f32 v[172:173], v[84:85], v[152:153]
    v_pk_mul_f32 v[174:175], v[86:87], v[154:155]
    v_pk_mul_f32 v[208:209], v[120:121], v[156:157]
    v_pk_mul_f32 v[210:211], v[122:123], v[158:159]
    v_pk_mul_f32 v[152:153], v[88:89], v[88:89]
    v_pk_mul_f32 v[154:155], v[90:91], v[90:91]
    v_pk_mul_f32 v[156:157], v[124:125], v[124:125]
    v_pk_mul_f32 v[158:159], v[126:127], v[126:127]
    v_pk_fma_f32 v[152:153], v[152:153], s[40:41], v[244:245]
    v_pk_fma_f32 v[154:155], v[154:155], s[40:41], v[244:245]
    v_pk_fma_f32 v[156:157], v[156:157], s[40:41], v[244:245]
    v_pk_fma_f32 v[158:159], v[158:159], s[40:41], v[244:245]
    v_pk_mul_f32 v[152:153], v[152:153], v[88:89]
    v_pk_mul_f32 v[154:155], v[154:155], v[90:91]
    v_pk_mul_f32 v[156:157], v[156:157], v[124:125]
    v_pk_mul_f32 v[158:159], v[158:159], v[126:127]
    v_exp_f32 v152, v152
    v_exp_f32 v153, v153
    v_exp_f32 v154, v154
    v_exp_f32 v155, v155
    v_exp_f32 v156, v156
    v_exp_f32 v157, v157
    v_exp_f32 v158, v158
    v_exp_f32 v159, v159
    v_pk_add_f32 v[152:153], v[152:153], 1.0 op_sel_hi:[1,0]
    v_pk_add_f32 v[154:155], v[154:155], 1.0 op_sel_hi:[1,0]
    v_pk_add_f32 v[156:157], v[156:157], 1.0 op_sel_hi:[1,0]
    v_pk_add_f32 v[158:159], v[158:159], 1.0 op_sel_hi:[1,0]
    v_rcp_f32 v152, v152
    v_rcp_f32 v153, v153
    v_rcp_f32 v154, v154
    v_rcp_f32 v155, v155
    v_rcp_f32 v156, v156
    v_rcp_f32 v157, v157
    v_rcp_f32 v158, v158
    v_rcp_f32 v159, v159
    v_pk_mul_f32 v[176:177], v[88:89], v[152:153]
    v_pk_mul_f32 v[178:179], v[90:91], v[154:155]
    v_pk_mul_f32 v[212:213], v[124:125], v[156:157]
    v_pk_mul_f32 v[214:215], v[126:127], v[158:159]
    v_pk_mul_f32 v[152:153], v[92:93], v[92:93]
    v_pk_mul_f32 v[154:155], v[94:95], v[94:95]
    v_pk_mul_f32 v[156:157], v[128:129], v[128:129]
    v_pk_mul_f32 v[158:159], v[130:131], v[130:131]
    v_pk_fma_f32 v[152:153], v[152:153], s[40:41], v[244:245]
    v_pk_fma_f32 v[154:155], v[154:155], s[40:41], v[244:245]
    v_pk_fma_f32 v[156:157], v[156:157], s[40:41], v[244:245]
    v_pk_fma_f32 v[158:159], v[158:159], s[40:41], v[244:245]
    v_pk_mul_f32 v[152:153], v[152:153], v[92:93]
    v_pk_mul_f32 v[154:155], v[154:155], v[94:95]
    v_pk_mul_f32 v[156:157], v[156:157], v[128:129]
    v_pk_mul_f32 v[158:159], v[158:159], v[130:131]
    v_exp_f32 v152, v152
    v_exp_f32 v153, v153
    v_exp_f32 v154, v154
    v_exp_f32 v155, v155
    v_exp_f32 v156, v156
    v_exp_f32 v157, v157
    v_exp_f32 v158, v158
    v_exp_f32 v159, v159
    v_pk_add_f32 v[152:153], v[152:153], 1.0 op_sel_hi:[1,0]
    v_pk_add_f32 v[154:155], v[154:155], 1.0 op_sel_hi:[1,0]
    v_pk_add_f32 v[156:157], v[156:157], 1.0 op_sel_hi:[1,0]
    v_pk_add_f32 v[158:159], v[158:159], 1.0 op_sel_hi:[1,0]
    v_rcp_f32 v152, v152
    v_rcp_f32 v153, v153
    v_rcp_f32 v154, v154
    v_rcp_f32 v155, v155
    v_rcp_f32 v156, v156
    v_rcp_f32 v157, v157
    v_rcp_f32 v158, v158
    v_rcp_f32 v159, v159
    v_pk_mul_f32 v[180:181], v[92:93], v[152:153]
    v_pk_mul_f32 v[182:183], v[94:95], v[154:155]
    v_pk_mul_f32 v[216:217], v[128:129], v[156:157]
    v_pk_mul_f32 v[218:219], v[130:131], v[158:159]
    v_pk_mul_f32 v[152:153], v[96:97], v[96:97]
    v_pk_mul_f32 v[154:155], v[98:99], v[98:99]
    v_pk_mul_f32 v[156:157], v[132:133], v[132:133]
    v_pk_mul_f32 v[158:159], v[134:135], v[134:135]
    v_pk_fma_f32 v[152:153], v[152:153], s[40:41], v[244:245]
    v_pk_fma_f32 v[154:155], v[154:155], s[40:41], v[244:245]
    v_pk_fma_f32 v[156:157], v[156:157], s[40:41], v[244:245]
    v_pk_fma_f32 v[158:159], v[158:159], s[40:41], v[244:245]
    v_pk_mul_f32 v[152:153], v[152:153], v[96:97]
    v_pk_mul_f32 v[154:155], v[154:155], v[98:99]
    v_pk_mul_f32 v[156:157], v[156:157], v[132:133]
    v_pk_mul_f32 v[158:159], v[158:159], v[134:135]
    v_exp_f32 v152, v152
    v_exp_f32 v153, v153
    v_exp_f32 v154, v154
    v_exp_f32 v155, v155
    v_exp_f32 v156, v156
    v_exp_f32 v157, v157
    v_exp_f32 v158, v158
    v_exp_f32 v159, v159
    v_pk_add_f32 v[152:153], v[152:153], 1.0 op_sel_hi:[1,0]
    v_pk_add_f32 v[154:155], v[154:155], 1.0 op_sel_hi:[1,0]
    v_pk_add_f32 v[156:157], v[156:157], 1.0 op_sel_hi:[1,0]
    v_pk_add_f32 v[158:159], v[158:159], 1.0 op_sel_hi:[1,0]
    v_rcp_f32 v152, v152
    v_rcp_f32 v153, v153
    v_rcp_f32 v154, v154
    v_rcp_f32 v155, v155
    v_rcp_f32 v156, v156
    v_rcp_f32 v157, v157
    v_rcp_f32 v158, v158
    v_rcp_f32 v159, v159
    v_pk_mul_f32 v[184:185], v[96:97], v[152:153]
    v_pk_mul_f32 v[186:187], v[98:99], v[154:155]
    v_pk_mul_f32 v[220:221], v[132:133], v[156:157]
    v_pk_mul_f32 v[222:223], v[134:135], v[158:159]
    v_pk_mul_f32 v[152:153], v[100:101], v[100:101]
    v_pk_mul_f32 v[154:155], v[102:103], v[102:103]
    v_pk_mul_f32 v[156:157], v[136:137], v[136:137]
    v_pk_mul_f32 v[158:159], v[138:139], v[138:139]
    v_pk_fma_f32 v[152:153], v[152:153], s[40:41], v[244:245]
    v_pk_fma_f32 v[154:155], v[154:155], s[40:41], v[244:245]
    v_pk_fma_f32 v[156:157], v[156:157], s[40:41], v[244:245]
    v_pk_fma_f32 v[158:159], v[158:159], s[40:41], v[244:245]
    v_pk_mul_f32 v[152:153], v[152:153], v[100:101]
    v_pk_mul_f32 v[154:155], v[154:155], v[102:103]
    v_pk_mul_f32 v[156:157], v[156:157], v[136:137]
    v_pk_mul_f32 v[158:159], v[158:159], v[138:139]
    v_exp_f32 v152, v152
    v_exp_f32 v153, v153
    v_exp_f32 v154, v154
    v_exp_f32 v155, v155
    v_exp_f32 v156, v156
    v_exp_f32 v157, v157
    v_exp_f32 v158, v158
    v_exp_f32 v159, v159
    v_pk_add_f32 v[152:153], v[152:153], 1.0 op_sel_hi:[1,0]
    v_pk_add_f32 v[154:155], v[154:155], 1.0 op_sel_hi:[1,0]
    v_pk_add_f32 v[156:157], v[156:157], 1.0 op_sel_hi:[1,0]
    v_pk_add_f32 v[158:159], v[158:159], 1.0 op_sel_hi:[1,0]
    v_rcp_f32 v152, v152
    v_rcp_f32 v153, v153
    v_rcp_f32 v154, v154
    v_rcp_f32 v155, v155
    v_rcp_f32 v156, v156
    v_rcp_f32 v157, v157
    v_rcp_f32 v158, v158
    v_rcp_f32 v159, v159
    v_pk_mul_f32 v[188:189], v[100:101], v[152:153]
    v_pk_mul_f32 v[190:191], v[102:103], v[154:155]
    v_pk_mul_f32 v[224:225], v[136:137], v[156:157]
    v_pk_mul_f32 v[226:227], v[138:139], v[158:159]
    v_pk_mul_f32 v[152:153], v[104:105], v[104:105]
    v_pk_mul_f32 v[154:155], v[106:107], v[106:107]
    v_pk_mul_f32 v[156:157], v[140:141], v[140:141]
    v_pk_mul_f32 v[158:159], v[142:143], v[142:143]
    v_pk_fma_f32 v[152:153], v[152:153], s[40:41], v[244:245]
    v_pk_fma_f32 v[154:155], v[154:155], s[40:41], v[244:245]
    v_pk_fma_f32 v[156:157], v[156:157], s[40:41], v[244:245]
    v_pk_fma_f32 v[158:159], v[158:159], s[40:41], v[244:245]
    v_pk_mul_f32 v[152:153], v[152:153], v[104:105]
    v_pk_mul_f32 v[154:155], v[154:155], v[106:107]
    v_pk_mul_f32 v[156:157], v[156:157], v[140:141]
    v_pk_mul_f32 v[158:159], v[158:159], v[142:143]
    v_exp_f32 v152, v152
    v_exp_f32 v153, v153
    v_exp_f32 v154, v154
    v_exp_f32 v155, v155
    v_exp_f32 v156, v156
    v_exp_f32 v157, v157
    v_exp_f32 v158, v158
    v_exp_f32 v159, v159
    v_pk_add_f32 v[152:153], v[152:153], 1.0 op_sel_hi:[1,0]
    v_pk_add_f32 v[154:155], v[154:155], 1.0 op_sel_hi:[1,0]
    v_pk_add_f32 v[156:157], v[156:157], 1.0 op_sel_hi:[1,0]
    v_pk_add_f32 v[158:159], v[158:159], 1.0 op_sel_hi:[1,0]
    v_rcp_f32 v152, v152
    v_rcp_f32 v153, v153
    v_rcp_f32 v154, v154
    v_rcp_f32 v155, v155
    v_rcp_f32 v156, v156
    v_rcp_f32 v157, v157
    v_rcp_f32 v158, v158
    v_rcp_f32 v159, v159
    v_pk_mul_f32 v[192:193], v[104:105], v[152:153]
    v_pk_mul_f32 v[194:195], v[106:107], v[154:155]
    v_pk_mul_f32 v[228:229], v[140:141], v[156:157]
    v_pk_mul_f32 v[230:231], v[142:143], v[158:159]
    v_pk_mul_f32 v[152:153], v[108:109], v[108:109]
    v_pk_mul_f32 v[154:155], v[110:111], v[110:111]
    v_pk_mul_f32 v[156:157], v[144:145], v[144:145]
    v_pk_mul_f32 v[158:159], v[146:147], v[146:147]
    v_pk_fma_f32 v[152:153], v[152:153], s[40:41], v[244:245]
    v_pk_fma_f32 v[154:155], v[154:155], s[40:41], v[244:245]
    v_pk_fma_f32 v[156:157], v[156:157], s[40:41], v[244:245]
    v_pk_fma_f32 v[158:159], v[158:159], s[40:41], v[244:245]
    v_pk_mul_f32 v[152:153], v[152:153], v[108:109]
    v_pk_mul_f32 v[154:155], v[154:155], v[110:111]
    v_pk_mul_f32 v[156:157], v[156:157], v[144:145]
    v_pk_mul_f32 v[158:159], v[158:159], v[146:147]
    v_exp_f32 v152, v152
    v_exp_f32 v153, v153
    v_exp_f32 v154, v154
    v_exp_f32 v155, v155
    v_exp_f32 v156, v156
    v_exp_f32 v157, v157
    v_exp_f32 v158, v158
    v_exp_f32 v159, v159
    v_pk_add_f32 v[152:153], v[152:153], 1.0 op_sel_hi:[1,0]
    v_pk_add_f32 v[154:155], v[154:155], 1.0 op_sel_hi:[1,0]
    v_pk_add_f32 v[156:157], v[156:157], 1.0 op_sel_hi:[1,0]
    v_pk_add_f32 v[158:159], v[158:159], 1.0 op_sel_hi:[1,0]
    v_rcp_f32 v152, v152
    v_rcp_f32 v153, v153
    v_rcp_f32 v154, v154
    v_rcp_f32 v155, v155
    v_rcp_f32 v156, v156
    v_rcp_f32 v157, v157
    v_rcp_f32 v158, v158
    v_rcp_f32 v159, v159
    v_pk_mul_f32 v[196:197], v[108:109], v[152:153]
    v_pk_mul_f32 v[198:199], v[110:111], v[154:155]
    v_pk_mul_f32 v[232:233], v[144:145], v[156:157]
    v_pk_mul_f32 v[234:235], v[146:147], v[158:159]
    v_pk_mul_f32 v[152:153], v[112:113], v[112:113]
    v_pk_mul_f32 v[154:155], v[114:115], v[114:115]
    v_pk_mul_f32 v[156:157], v[148:149], v[148:149]
    v_pk_mul_f32 v[158:159], v[150:151], v[150:151]
    v_pk_fma_f32 v[152:153], v[152:153], s[40:41], v[244:245]
    v_pk_fma_f32 v[154:155], v[154:155], s[40:41], v[244:245]
    v_pk_fma_f32 v[156:157], v[156:157], s[40:41], v[244:245]
    v_pk_fma_f32 v[158:159], v[158:159], s[40:41], v[244:245]
    v_pk_mul_f32 v[152:153], v[152:153], v[112:113]
    v_pk_mul_f32 v[154:155], v[154:155], v[114:115]
    v_pk_mul_f32 v[156:157], v[156:157], v[148:149]
    v_pk_mul_f32 v[158:159], v[158:159], v[150:151]
    v_exp_f32 v152, v152
    v_exp_f32 v153, v153
    v_exp_f32 v154, v154
    v_exp_f32 v155, v155
    v_exp_f32 v156, v156
    v_exp_f32 v157, v157
    v_exp_f32 v158, v158
    v_exp_f32 v159, v159
    v_pk_add_f32 v[152:153], v[152:153], 1.0 op_sel_hi:[1,0]
    v_pk_add_f32 v[154:155], v[154:155], 1.0 op_sel_hi:[1,0]
    v_pk_add_f32 v[156:157], v[156:157], 1.0 op_sel_hi:[1,0]
    v_pk_add_f32 v[158:159], v[158:159], 1.0 op_sel_hi:[1,0]
    v_rcp_f32 v152, v152
    v_rcp_f32 v153, v153
    v_rcp_f32 v154, v154
    v_rcp_f32 v155, v155
    v_rcp_f32 v156, v156
    v_rcp_f32 v157, v157
    v_rcp_f32 v158, v158
    v_rcp_f32 v159, v159
    v_pk_mul_f32 v[200:201], v[112:113], v[152:153]
    v_pk_mul_f32 v[202:203], v[114:115], v[154:155]
    v_pk_mul_f32 v[236:237], v[148:149], v[156:157]
    v_pk_mul_f32 v[238:239], v[150:151], v[158:159]
    s_mov_b32 s31, 0
    s_add_u32 s29, s30, 16384
    v_add_u32 v6, s29, v7
    s_barrier
    s_setprio 1
    ds_read_b128 v[152:155], v4 offset:0
    ds_read_b128 v[156:159], v4 offset:512
    ds_read_b128 v[80:83], v6 offset:0
    ds_read_b128 v[84:87], v6 offset:1024
    ds_read_b128 v[88:91], v6 offset:2048
    ds_read_b128 v[92:95], v6 offset:3072
    ds_read_b128 v[96:99], v6 offset:4096
    ds_read_b128 v[100:103], v6 offset:5120
    ds_read_b128 v[104:107], v6 offset:6144
    ds_read_b128 v[108:111], v6 offset:7168
    ds_read_b128 v[112:115], v6 offset:8192
    s_waitcnt lgkmcnt(0)
k2_loop:
    s_waitcnt lgkmcnt(8)
    v_mfma_f32_16x16x32_bf16 v[8:11], v[80:83], v[152:155], v[8:11]
    ds_read_b128 v[160:163], v5 offset:0
    v_mfma_f32_16x16x32_bf16 v[44:47], v[80:83], v[156:159], v[44:47]
    ds_read_b128 v[164:167], v5 offset:512
    s_waitcnt lgkmcnt(9)
    v_mfma_f32_16x16x32_bf16 v[12:15], v[84:87], v[152:155], v[12:15]
    ds_read_b128 v[116:119], v6 offset:9216
    v_mfma_f32_16x16x32_bf16 v[48:51], v[84:87], v[156:159], v[48:51]
    ds_read_b128 v[120:123], v6 offset:10240
    s_waitcnt lgkmcnt(10)
    v_mfma_f32_16x16x32_bf16 v[16:19], v[88:91], v[152:155], v[16:19]
    ds_read_b128 v[124:127], v6 offset:11264
    v_mfma_f32_16x16x32_bf16 v[52:55], v[88:91], v[156:159], v[52:55]
    ds_read_b128 v[128:131], v6 offset:12288
    s_waitcnt lgkmcnt(11)
    v_mfma_f32_16x16x32_bf16 v[20:23], v[92:95], v[152:155], v[20:23]
    ds_read_b128 v[132:135], v6 offset:13312
    v_mfma_f32_16x16x32_bf16 v[56:59], v[92:95], v[156:159], v[56:59]
    ds_read_b128 v[136:139], v6 offset:14336
    s_waitcnt lgkmcnt(12)
    v_mfma_f32_16x16x32_bf16 v[24:27], v[96:99], v[152:155], v[24:27]
    ds_read_b128 v[140:143], v6 offset:15360
    v_mfma_f32_16x16x32_bf16 v[60:63], v[96:99], v[156:159], v[60:63]
    ds_read_b128 v[144:147], v6 offset:16384
    s_waitcnt lgkmcnt(13)
    v_mfma_f32_16x16x32_bf16 v[28:31], v[100:103], v[152:155], v[28:31]
    ds_read_b128 v[148:151], v6 offset:17408
    v_mfma_f32_16x16x32_bf16 v[64:67], v[100:103], v[156:159], v[64:67]
    s_add_u32 s30, s30, 36864
    s_cmp_eq_u32 s30, 147456
    s_cselect_b32 s30, 0, s30
    s_cselect_b32 s29, -110592, s43
    s_waitcnt lgkmcnt(13)
    v_mfma_f32_16x16x32_bf16 v[32:35], v[104:107], v[152:155], v[32:35]
    v_add_u32 v4, s29, v4
    v_mfma_f32_16x16x32_bf16 v[68:71], v[104:107], v[156:159], v[68:71]
    v_add_u32 v5, s29, v5
    s_waitcnt lgkmcnt(12)
    v_mfma_f32_16x16x32_bf16 v[36:39], v[108:111], v[152:155], v[36:39]
    v_add_u32 v6, s29, v6
    v_mfma_f32_16x16x32_bf16 v[72:75], v[108:111], v[156:159], v[72:75]
    s_waitcnt lgkmcnt(11)
    v_mfma_f32_16x16x32_bf16 v[40:43], v[112:115], v[152:155], v[40:43]
    v_mfma_f32_16x16x32_bf16 v[76:79], v[112:115], v[156:159], v[76:79]
    s_waitcnt lgkmcnt(0)
    s_barrier
    v_mfma_f32_16x16x32_bf16 v[8:11], v[116:119], v[160:163], v[8:11]
    ds_read_b128 v[152:155], v4 offset:0
    v_mfma_f32_16x16x32_bf16 v[44:47], v[116:119], v[164:167], v[44:47]
    ds_read_b128 v[156:159], v4 offset:512
    v_mfma_f32_16x16x32_bf16 v[12:15], v[120:123], v[160:163], v[12:15]
    ds_read_b128 v[80:83], v6 offset:0
    v_mfma_f32_16x16x32_bf16 v[48:51], v[120:123], v[164:167], v[48:51]
    ds_read_b128 v[84:87], v6 offset:1024
    v_mfma_f32_16x16x32_bf16 v[16:19], v[124:127], v[160:163], v[16:19]
    ds_read_b128 v[88:91], v6 offset:2048
    v_mfma_f32_16x16x32_bf16 v[52:55], v[124:127], v[164:167], v[52:55]
    ds_read_b128 v[92:95], v6 offset:3072
    v_mfma_f32_16x16x32_bf16 v[20:23], v[128:131], v[160:163], v[20:23]
    ds_read_b128 v[96:99], v6 offset:4096
    v_mfma_f32_16x16x32_bf16 v[56:59], v[128:131], v[164:167], v[56:59]
    ds_read_b128 v[100:103], v6 offset:5120
    v_mfma_f32_16x16x32_bf16 v[24:27], v[132:135], v[160:163], v[24:27]
    ds_read_b128 v[104:107], v6 offset:6144
    v_mfma_f32_16x16x32_bf16 v[60:63], v[132:135], v[164:167], v[60:63]
    ds_read_b128 v[108:111], v6 offset:7168
    v_mfma_f32_16x16x32_bf16 v[28:31], v[136:139], v[160:163], v[28:31]
    ds_read_b128 v[112:115], v6 offset:8192
    v_mfma_f32_16x16x32_bf16 v[64:67], v[136:139], v[164:167], v[64:67]
    s_add_u32 s31, s31, 1
    s_cmp_lt_u32 s31, 32
    v_mfma_f32_16x16x32_bf16 v[32:35], v[140:143], v[160:163], v[32:35]
    v_mfma_f32_16x16x32_bf16 v[68:71], v[140:143], v[164:167], v[68:71]
    v_mfma_f32_16x16x32_bf16 v[36:39], v[144:147], v[160:163], v[36:39]
    v_mfma_f32_16x16x32_bf16 v[72:75], v[144:147], v[164:167], v[72:75]
    v_mfma_f32_16x16x32_bf16 v[40:43], v[148:151], v[160:163], v[40:43]
    v_mfma_f32_16x16x32_bf16 v[76:79], v[148:151], v[164:167], v[76:79]
    s_cbranch_scc1 k2_loop
    s_add_u32 s32, s18, 0x2000000
    s_addc_u32 s33, s19, 0
    s_mov_b32 s34, 0x900000
    s_mov_b32 s35, 0x20000
    s_lshl_b32 s36, s22, 3
    s_lshl_b32 s37, s27, 1
    s_add_u32 s36, s36, s37
    s_lshl_b32 s36, s36, 4
    s_add_u32 s36, s36, s23
    s_mul_i32 s36, s36, 4608
    s_add_u32 s37, s36, 4096
    v_lshlrev_b32 v6, 3, v1
    s_setprio 0
    v_pk_mul_f32 v[8:9], v[8:9], v[168:169]
    v_pk_mul_f32 v[10:11], v[10:11], v[170:171]
    v_cvt_pk_bf16_f32 v120, v8, v9
    v_cvt_pk_bf16_f32 v121, v10, v11
    v_pk_mul_f32 v[12:13], v[12:13], v[172:173]
    v_pk_mul_f32 v[14:15], v[14:15], v[174:175]
    v_cvt_pk_bf16_f32 v122, v12, v13
    v_cvt_pk_bf16_f32 v123, v14, v15
    buffer_store_dwordx4 v[120:123], v7, s[32:35], s36 offen offset:0 sc1
    v_pk_mul_f32 v[16:17], v[16:17], v[176:177]
    v_pk_mul_f32 v[18:19], v[18:19], v[178:179]
    v_cvt_pk_bf16_f32 v124, v16, v17
    v_cvt_pk_bf16_f32 v125, v18, v19
    v_pk_mul_f32 v[20:21], v[20:21], v[180:181]
    v_pk_mul_f32 v[22:23], v[22:23], v[182:183]
    v_cvt_pk_bf16_f32 v126, v20, v21
    v_cvt_pk_bf16_f32 v127, v22, v23
    buffer_store_dwordx4 v[124:127], v7, s[32:35], s36 offen offset:1024 sc1
    v_pk_mul_f32 v[24:25], v[24:25], v[184:185]
    v_pk_mul_f32 v[26:27], v[26:27], v[186:187]
    v_cvt_pk_bf16_f32 v128, v24, v25
    v_cvt_pk_bf16_f32 v129, v26, v27
    v_pk_mul_f32 v[28:29], v[28:29], v[188:189]
    v_pk_mul_f32 v[30:31], v[30:31], v[190:191]
    v_cvt_pk_bf16_f32 v130, v28, v29
    v_cvt_pk_bf16_f32 v131, v30, v31
    buffer_store_dwordx4 v[128:131], v7, s[32:35], s36 offen offset:2048 sc1
    v_pk_mul_f32 v[32:33], v[32:33], v[192:193]
    v_pk_mul_f32 v[34:35], v[34:35], v[194:195]
    v_cvt_pk_bf16_f32 v132, v32, v33
    v_cvt_pk_bf16_f32 v133, v34, v35
    v_pk_mul_f32 v[36:37], v[36:37], v[196:197]
    v_pk_mul_f32 v[38:39], v[38:39], v[198:199]
    v_cvt_pk_bf16_f32 v134, v36, v37
    v_cvt_pk_bf16_f32 v135, v38, v39
    buffer_store_dwordx4 v[132:135], v7, s[32:35], s36 offen offset:3072 sc1
    v_pk_mul_f32 v[40:41], v[40:41], v[200:201]
    v_pk_mul_f32 v[42:43], v[42:43], v[202:203]
    v_cvt_pk_bf16_f32 v136, v40, v41
    v_cvt_pk_bf16_f32 v137, v42, v43
    buffer_store_dwordx2 v[136:137], v6, s[32:35], s37 offen sc1
    s_add_u32 s36, s36, 73728
    s_add_u32 s37, s37, 73728
    v_pk_mul_f32 v[44:45], v[44:45], v[204:205]
    v_pk_mul_f32 v[46:47], v[46:47], v[206:207]
    v_cvt_pk_bf16_f32 v140, v44, v45
    v_cvt_pk_bf16_f32 v141, v46, v47
    v_pk_mul_f32 v[48:49], v[48:49], v[208:209]
    v_pk_mul_f32 v[50:51], v[50:51], v[210:211]
    v_cvt_pk_bf16_f32 v142, v48, v49
    v_cvt_pk_bf16_f32 v143, v50, v51
    buffer_store_dwordx4 v[140:143], v7, s[32:35], s36 offen offset:0 sc1
    v_pk_mul_f32 v[52:53], v[52:53], v[212:213]
    v_pk_mul_f32 v[54:55], v[54:55], v[214:215]
    v_cvt_pk_bf16_f32 v120, v52, v53
    v_cvt_pk_bf16_f32 v121, v54, v55
    v_pk_mul_f32 v[56:57], v[56:57], v[216:217]
    v_pk_mul_f32 v[58:59], v[58:59], v[218:219]
    v_cvt_pk_bf16_f32 v122, v56, v57
    v_cvt_pk_bf16_f32 v123, v58, v59
    buffer_store_dwordx4 v[120:123], v7, s[32:35], s36 offen offset:1024 sc1
    v_pk_mul_f32 v[60:61], v[60:61], v[220:221]
    v_pk_mul_f32 v[62:63], v[62:63], v[222:223]
    v_cvt_pk_bf16_f32 v124, v60, v61
    v_cvt_pk_bf16_f32 v125, v62, v63
    v_pk_mul_f32 v[64:65], v[64:65], v[224:225]
    v_pk_mul_f32 v[66:67], v[66:67], v[226:227]
    v_cvt_pk_bf16_f32 v126, v64, v65
    v_cvt_pk_bf16_f32 v127, v66, v67
    buffer_store_dwordx4 v[124:127], v7, s[32:35], s36 offen offset:2048 sc1
    v_pk_mul_f32 v[68:69], v[68:69], v[228:229]
    v_pk_mul_f32 v[70:71], v[70:71], v[230:231]
    v_cvt_pk_bf16_f32 v128, v68, v69
    v_cvt_pk_bf16_f32 v129, v70, v71
    v_pk_mul_f32 v[72:73], v[72:73], v[232:233]
    v_pk_mul_f32 v[74:75], v[74:75], v[234:235]
    v_cvt_pk_bf16_f32 v130, v72, v73
    v_cvt_pk_bf16_f32 v131, v74, v75
    buffer_store_dwordx4 v[128:131], v7, s[32:35], s36 offen offset:3072 sc1
    v_pk_mul_f32 v[76:77], v[76:77], v[236:237]
    v_pk_mul_f32 v[78:79], v[78:79], v[238:239]
    v_cvt_pk_bf16_f32 v132, v76, v77
    v_cvt_pk_bf16_f32 v133, v78, v79
    buffer_store_dwordx2 v[132:133], v6, s[32:35], s37 offen sc1
    s_waitcnt lgkmcnt(0)
    s_barrier
    s_lshl_b32 s36, s22, 2
    s_add_u32 s36, s36, s27
    s_lshl_b32 s36, s36, 4
    s_add_u32 s36, s36, s23
    s_lshl_b32 s36, s36, 4
    s_add_u32 s36, s36, 0x20000
    s_and_b32 s58, s20, 1
    s_lshl_b32 s55, s58, 2
    s_add_u32 s55, s55, s52
    s_mul_i32 s55, s55, 30
    s_add_u32 s55, s55, s21
    s_cmp_ge_u32 s21, 30
    s_cselect_b32 s55, 255, s55
    s_lshl_b32 s58, s58, 1
    s_lshl_b32 s59, s52, 2
    s_add_u32 s58, s58, s59
    s_mul_i32 s56, s55, 7282
    s_lshr_b32 s56, s56, 16
    s_mul_i32 s57, s56, 9
    s_sub_u32 s57, s55, s57
    v_lshrrev_b32 v4, 2, v2
    v_lshl_add_u32 v4, v3, 2, v4
    v_lshrrev_b32 v5, 1, v4
    v_and_b32 v5, 3, v5
    v_xor_b32 v5, s27, v5
    v_lshlrev_b32 v5, 5, v5
    v_lshl_add_u32 v4, v4, 7, v5
    v_and_b32 v5, 3, v1
    v_lshl_add_u32 v4, v5, 3, v4
    v_add_u32 v14, 24576, v4
    v_mov_b32 v12, v7
    v_mov_b32 v13, v6
    v_mov_b64 v[16:17], 0
    v_mov_b64 v[18:19], 0
    v_mov_b64 v[20:21], 0
    v_mov_b64 v[22:23], 0
    v_mov_b64 v[24:25], 0
    v_mov_b64 v[26:27], 0
    v_mov_b64 v[28:29], 0
    v_mov_b64 v[30:31], 0
    v_mov_b64 v[32:33], 0
    v_mov_b64 v[34:35], 0
    s_mul_i32 s38, s56, 5
    s_lshr_b32 s38, s38, 1
    v_add_u32 v8, s38, v5
    v_lshrrev_b32 v9, 2, v1
    v_add_u32 v9, s58, v9
    v_and_b32 v9, 15, v9
    v_cmp_gt_u32 s[60:61], 64, v8
    v_cmp_gt_u32 vcc, 3, v5
    v_lshl_add_u32 v8, v8, 4, v9
    v_lshlrev_b32 v8, 4, v8
    s_nop 1
    s_and_b64 s[60:61], s[60:61], vcc
    s_mov_b32 s30, 0
    s_mov_b32 s31, 0
    s_mov_b32 s43, 45056
    s_mov_b32 s38, 0x20000
    s_waitcnt vmcnt(0)
    s_mov_b64 exec, 1
    buffer_store_dword v243, off, s[64:67], s36 sc1
    s_mov_b64 exec, -1
    s_cmp_ge_u32 s55, 234
    s_cbranch_scc1 k3_skip
    s_cmp_eq_u32 s27, 0
    s_cselect_b32 s62, 0, 16
    s_mov_b32 s63, 3
    s_mov_b32 s73, 0
    s_waitcnt vmcnt(0)
    s_barrier
    s_cmp_ge_u32 s62, 16
    s_cbranch_scc1 hg_done0
    buffer_load_dword v9, v8, s[64:67], s38 offen sc1
    s_branch hg_chk0
hg_again0:
    s_sleep 4
    buffer_load_dword v9, v8, s[64:67], s38 offen sc1
hg_chk0:
    s_waitcnt vmcnt(0)
    v_cmp_ne_u32 vcc, s72, v9
    s_add_u32 s73, s73, 1
    s_nop 3
    s_and_b64 vcc, vcc, s[60:61]
    s_ff1_i32_b64 s62, vcc
    s_lshr_b32 s62, s62, 2
    s_cmp_ge_u32 s73, 262144
    s_cselect_b32 s62, 16, s62
    s_cmp_lt_u32 s62, s63
    s_cbranch_scc1 hg_again0
    s_cmp_ge_u32 s62, 16
    s_cbranch_scc1 hg_done0
    buffer_load_dword v9, v8, s[64:67], s38 offen sc1
hg_done0:
    s_waitcnt lgkmcnt(0)
    s_barrier
    s_barrier
    ds_read_b64_tr_b16 v[136:137], v14 offset:0
    ds_read_b64_tr_b16 v[138:139], v14 offset:2048
    ds_read_b128 v[40:43], v12 offset:0
    ds_read_b128 v[44:47], v12 offset:4608
    ds_read_b128 v[48:51], v12 offset:9216
    ds_read_b128 v[52:55], v12 offset:13824
    ds_read_b128 v[56:59], v12 offset:18432
    ds_read_b64_tr_b16 v[140:141], v14 offset:4096
    ds_read_b64_tr_b16 v[142:143], v14 offset:6144
    ds_read_b128 v[60:63], v12 offset:1024
    ds_read_b128 v[64:67], v12 offset:5632
    ds_read_b128 v[68:71], v12 offset:10240
    ds_read_b128 v[72:75], v12 offset:14848
    ds_read_b128 v[76:79], v12 offset:19456
k3_loop:
    s_waitcnt lgkmcnt(11)
    v_mfma_f32_16x16x32_bf16 v[16:19], v[136:139], v[40:43], v[16:19]
    ds_read_b64_tr_b16 v[144:145], v14 offset:8192
    ds_read_b64_tr_b16 v[146:147], v14 offset:10240
    s_waitcnt lgkmcnt(12)
    v_mfma_f32_16x16x32_bf16 v[20:23], v[136:139], v[44:47], v[20:23]
    ds_read_b128 v[80:83], v12 offset:2048
    ds_read_b128 v[84:87], v12 offset:6656
    s_waitcnt lgkmcnt(13)
    v_mfma_f32_16x16x32_bf16 v[24:27], v[136:139], v[48:51], v[24:27]
    ds_read_b128 v[88:91], v12 offset:11264
    ds_read_b128 v[92:95], v12 offset:15872
    s_waitcnt lgkmcnt(14)
    v_mfma_f32_16x16x32_bf16 v[28:31], v[136:139], v[52:55], v[28:31]
    ds_read_b128 v[96:99], v12 offset:20480
    ds_read_b64_tr_b16 v[148:149], v14 offset:12288
    s_waitcnt lgkmcnt(15)
    v_mfma_f32_16x16x32_bf16 v[32:35], v[136:139], v[56:59], v[32:35]
    ds_read_b64_tr_b16 v[150:151], v14 offset:14336
    ds_read_b128 v[100:103], v12 offset:3072
    s_waitcnt lgkmcnt(14)
    v_mfma_f32_16x16x32_bf16 v[16:19], v[140:143], v[60:63], v[16:19]
    ds_read_b128 v[104:107], v12 offset:7680
    ds_read_b128 v[108:111], v12 offset:12288
    s_waitcnt lgkmcnt(15)
    v_mfma_f32_16x16x32_bf16 v[20:23], v[140:143], v[64:67], v[20:23]
    ds_read_b128 v[112:115], v12 offset:16896
    ds_read_b128 v[116:119], v12 offset:21504
    s_waitcnt lgkmcnt(15)
    v_mfma_f32_16x16x32_bf16 v[24:27], v[140:143], v[68:71], v[24:27]
    ds_read_b64_tr_b16 v[152:153], v14 offset:16384
    ds_read_b64 v[120:121], v13 offset:4096
    v_mfma_f32_16x16x32_bf16 v[28:31], v[140:143], v[72:75], v[28:31]
    ds_read_b64 v[122:123], v13 offset:8704
    ds_read_b64 v[124:125], v13 offset:13312
    s_waitcnt lgkmcnt(15)
    v_mfma_f32_16x16x32_bf16 v[32:35], v[140:143], v[76:79], v[32:35]
    ds_read_b64 v[126:127], v13 offset:17920
    ds_read_b64 v[128:129], v13 offset:22528
    v_mfma_f32_16x16x32_bf16 v[16:19], v[144:147], v[80:83], v[16:19]
    s_add_u32 s30, s30, 45056
    s_cmp_eq_u32 s30, 135168
    s_cselect_b32 s30, 0, s30
    s_cselect_b32 s29, -90112, s43
    v_add_u32 v12, s29, v12
    s_waitcnt lgkmcnt(15)
    v_mfma_f32_16x16x32_bf16 v[20:23], v[144:147], v[84:87], v[20:23]
    v_add_u32 v13, s29, v13
    v_add_u32 v14, s29, v14
    v_mfma_f32_16x16x32_bf16 v[24:27], v[144:147], v[88:91], v[24:27]
    s_add_u32 s31, s31, 1
    s_add_u32 s63, s31, 3
    s_min_u32 s63, s63, 16
    s_waitcnt lgkmcnt(14)
    v_mfma_f32_16x16x32_bf16 v[28:31], v[144:147], v[92:95], v[28:31]
    s_waitcnt lgkmcnt(13)
    v_mfma_f32_16x16x32_bf16 v[32:35], v[144:147], v[96:99], v[32:35]
    s_waitcnt lgkmcnt(10)
    v_mfma_f32_16x16x32_bf16 v[16:19], v[148:151], v[100:103], v[16:19]
    s_waitcnt lgkmcnt(9)
    v_mfma_f32_16x16x32_bf16 v[20:23], v[148:151], v[104:107], v[20:23]
    s_waitcnt lgkmcnt(8)
    v_mfma_f32_16x16x32_bf16 v[24:27], v[148:151], v[108:111], v[24:27]
    s_waitcnt lgkmcnt(7)
    v_mfma_f32_16x16x32_bf16 v[28:31], v[148:151], v[112:115], v[28:31]
    s_waitcnt lgkmcnt(6)
    v_mfma_f32_16x16x32_bf16 v[32:35], v[148:151], v[116:119], v[32:35]
    s_waitcnt lgkmcnt(0)
    s_cmp_eq_u32 s31, 16
    s_cbranch_scc1 k3_nb
    s_cmp_ge_u32 s62, 16
    s_cbranch_scc1 hg_done1
    s_branch hg_chk1
hg_again1:
    s_sleep 4
    buffer_load_dword v9, v8, s[64:67], s38 offen sc1
hg_chk1:
    s_waitcnt vmcnt(0)
    v_cmp_ne_u32 vcc, s72, v9
    s_add_u32 s73, s73, 1
    s_nop 3
    s_and_b64 vcc, vcc, s[60:61]
    s_ff1_i32_b64 s62, vcc
    s_lshr_b32 s62, s62, 2
    s_cmp_ge_u32 s73, 262144
    s_cselect_b32 s62, 16, s62
    s_cmp_lt_u32 s62, s63
    s_cbranch_scc1 hg_again1
    s_cmp_ge_u32 s62, 16
    s_cbranch_scc1 hg_done1
    buffer_load_dword v9, v8, s[64:67], s38 offen sc1
hg_done1:
    s_barrier
k3_nb:
    v_mfma_f32_16x16x16_bf16 v[16:19], v[152:153], v[120:121], v[16:19]
    ds_read_b64_tr_b16 v[136:137], v14 offset:0
    ds_read_b64_tr_b16 v[138:139], v14 offset:2048
    ds_read_b128 v[40:43], v12 offset:0
    v_mfma_f32_16x16x16_bf16 v[20:23], v[152:153], v[122:123], v[20:23]
    ds_read_b128 v[44:47], v12 offset:4608
    ds_read_b128 v[48:51], v12 offset:9216
    ds_read_b128 v[52:55], v12 offset:13824
    v_mfma_f32_16x16x16_bf16 v[24:27], v[152:153], v[124:125], v[24:27]
    ds_read_b128 v[56:59], v12 offset:18432
    ds_read_b64_tr_b16 v[140:141], v14 offset:4096
    ds_read_b64_tr_b16 v[142:143], v14 offset:6144
    v_mfma_f32_16x16x16_bf16 v[28:31], v[152:153], v[126:127], v[28:31]
    ds_read_b128 v[60:63], v12 offset:1024
    ds_read_b128 v[64:67], v12 offset:5632
    ds_read_b128 v[68:71], v12 offset:10240
    v_mfma_f32_16x16x16_bf16 v[32:35], v[152:153], v[128:129], v[32:35]
    ds_read_b128 v[72:75], v12 offset:14848
    ds_read_b128 v[76:79], v12 offset:19456
    s_cmp_lt_u32 s31, 16
    s_cbranch_scc1 k3_loop
    s_waitcnt lgkmcnt(0)
    s_mov_b32 s32, s14
    s_mov_b32 s33, s15
    s_mov_b32 s34, 0x240000
    s_mov_b32 s35, 0x20000
    s_movk_i32 s36, 1152
    v_mul_lo_u32 v4, v240, s36
    s_lshl_b32 s36, s57, 7
    s_lshl_b32 s37, s27, 5
    s_add_u32 s36, s36, s37
    v_lshl_add_u32 v4, v3, 3, v4
    v_add_u32 v4, s36, v4
    s_mul_i32 s38, s56, 5
    s_add_u32 s36, s38, 0
    s_and_b32 s37, s36, 1
    s_lshr_b32 s36, s36, 1
    s_lshl_b32 s36, s36, 3
    s_add_u32 s36, s36, s37
    s_mul_i32 s36, s36, 4608
    v_cvt_pk_bf16_f32 v40, v16, v17
    v_cvt_pk_bf16_f32 v41, v18, v19
    buffer_store_dwordx2 v[40:41], v4, s[32:35], s36 offen
    s_add_u32 s36, s38, 1
    s_and_b32 s37, s36, 1
    s_lshr_b32 s36, s36, 1
    s_lshl_b32 s36, s36, 3
    s_add_u32 s36, s36, s37
    s_mul_i32 s36, s36, 4608
    v_cvt_pk_bf16_f32 v42, v20, v21
    v_cvt_pk_bf16_f32 v43, v22, v23
    buffer_store_dwordx2 v[42:43], v4, s[32:35], s36 offen
    s_add_u32 s36, s38, 2
    s_and_b32 s37, s36, 1
    s_lshr_b32 s36, s36, 1
    s_lshl_b32 s36, s36, 3
    s_add_u32 s36, s36, s37
    s_mul_i32 s36, s36, 4608
    v_cvt_pk_bf16_f32 v44, v24, v25
    v_cvt_pk_bf16_f32 v45, v26, v27
    buffer_store_dwordx2 v[44:45], v4, s[32:35], s36 offen
    s_add_u32 s36, s38, 3
    s_and_b32 s37, s36, 1
    s_lshr_b32 s36, s36, 1
    s_lshl_b32 s36, s36, 3
    s_add_u32 s36, s36, s37
    s_mul_i32 s36, s36, 4608
    v_cvt_pk_bf16_f32 v46, v28, v29
    v_cvt_pk_bf16_f32 v47, v30, v31
    buffer_store_dwordx2 v[46:47], v4, s[32:35], s36 offen
    s_add_u32 s36, s38, 4
    s_and_b32 s37, s36, 1
    s_lshr_b32 s36, s36, 1
    s_lshl_b32 s36, s36, 3
    s_add_u32 s36, s36, s37
    s_mul_i32 s36, s36, 4608
    v_cvt_pk_bf16_f32 v48, v32, v33
    v_cvt_pk_bf16_f32 v49, v34, v35
    buffer_store_dwordx2 v[48:49], v4, s[32:35], s36 offen
k3_skip:
    s_endpgm
k_loader:
    s_setprio 0
    s_add_u32 s96, s53, s54
    s_mul_i32 s56, s96, 11
    s_lshr_b32 s56, s56, 5
    s_mul_i32 s56, s56, 3
    s_sub_u32 s96, s96, s56
    s_mul_i32 s56, s20, 11
    s_lshr_b32 s56, s56, 5
    s_mul_i32 s56, s56, 3
    s_sub_u32 s97, s20, s56
    s_mul_i32 s97, s97, 3
    s_mov_b32 s98, 3
    s_add_u32 s55, s96, s97
    s_lshl_b32 s36, s55, 7
    s_mul_i32 s37, s55, 589824
    v_lshrrev_b32 v4, 3, v1
    v_and_b32 v5, 7, v1
    s_lshl_b32 s28, s22, 7
    s_lshl_b32 s29, s27, 5
    s_add_u32 s28, s28, s29
    s_movk_i32 s29, 1152
    v_add_u32 v13, s28, v4
    v_mul_u32_u24 v6, s29, v13
    v_and_b32 v8, 1, v3
    v_xor_b32 v8, v8, v5
    v_xor_b32 v9, 0, v8
    v_lshl_add_u32 v9, v9, 4, v6
    v_add_u32 v16, 0, v9
    v_xor_b32 v9, 2, v8
    v_lshl_add_u32 v9, v9, 4, v6
    v_add_u32 v17, 8192, v9
    v_xor_b32 v9, 4, v8
    v_lshl_add_u32 v9, v9, 4, v6
    v_add_u32 v18, 16384, v9
    v_xor_b32 v9, 6, v8
    v_lshl_add_u32 v9, v9, 4, v6
    v_add_u32 v19, 24576, v9
    s_lshl_b32 s28, s27, 12
    s_mov_b32 m0, s28
    s_mov_b32 s30, 0
    s_waitcnt lgkmcnt(0)
    s_mov_b32 s32, s4
    s_mov_b32 s33, s5
    s_mov_b32 s34, 0x240000
    s_mov_b32 s35, 0x20000
    s_mov_b32 s64, s6
    s_mov_b32 s65, s7
    s_mov_b32 s66, 0x510000
    s_mov_b32 s67, 0x20000
    buffer_load_dwordx4 v16, s[32:35], s36 offen offset:0 lds
    buffer_load_dwordx4 v17, s[32:35], s36 offen offset:1024 lds
    buffer_load_dwordx4 v18, s[32:35], s36 offen offset:2048 lds
    buffer_load_dwordx4 v19, s[32:35], s36 offen offset:3072 lds
    s_mul_i32 s39, s23, 288
    s_add_u32 s39, s39, 4608
    s_mul_i32 s57, s27, 5120
    s_add_u32 s57, s57, 16384
    s_mul_i32 s58, s27, 320
    s_movk_i32 s59, 9216
    s_movk_i32 s56, 144
    v_mov_b32 v12, 0x7f000000
    v_add_u32 v14, s58, v1
    v_add_u32 v9, 0, v14
    v_mul_u32_u24 v10, 6899, v9
    v_lshrrev_b32 v10, 20, v10
    v_mul_u32_u24 v11, 152, v10
    v_sub_u32 v9, v9, v11
    v_mul_u32_u24 v11, 3641, v9
    v_lshrrev_b32 v11, 16, v11
    v_cmp_gt_u32 vcc, s56, v9
    v_lshl_add_u32 v10, v10, 3, v11
    v_mul_u32_u24 v11, 18, v11
    v_sub_u32 v9, v9, v11
    v_cmp_gt_u32 s[44:45], 64, v10
    v_mul_u32_u24 v11, s59, v10
    v_lshl_add_u32 v9, v9, 4, v11
    s_sub_u32 s60, s39, 0
    v_add_u32 v9, s60, v9
    s_and_b64 vcc, vcc, s[44:45]
    s_add_u32 m0, s57, 0
    v_cndmask_b32 v24, v12, v9, vcc
    buffer_load_dwordx4 v24, s[64:67], s37 offen offset:0 lds
    v_add_u32 v9, 64, v14
    v_mul_u32_u24 v10, 6899, v9
    v_lshrrev_b32 v10, 20, v10
    v_mul_u32_u24 v11, 152, v10
    v_sub_u32 v9, v9, v11
    v_mul_u32_u24 v11, 3641, v9
    v_lshrrev_b32 v11, 16, v11
    v_cmp_gt_u32 vcc, s56, v9
    v_lshl_add_u32 v10, v10, 3, v11
    v_mul_u32_u24 v11, 18, v11
    v_sub_u32 v9, v9, v11
    v_cmp_gt_u32 s[44:45], 64, v10
    v_mul_u32_u24 v11, s59, v10
    v_lshl_add_u32 v9, v9, 4, v11
    s_sub_u32 s60, s39, 1024
    v_add_u32 v9, s60, v9
    s_and_b64 vcc, vcc, s[44:45]
    v_cndmask_b32 v25, v12, v9, vcc
    buffer_load_dwordx4 v25, s[64:67], s37 offen offset:1024 lds
    v_add_u32 v9, 128, v14
    v_mul_u32_u24 v10, 6899, v9
    v_lshrrev_b32 v10, 20, v10
    v_mul_u32_u24 v11, 152, v10
    v_sub_u32 v9, v9, v11
    v_mul_u32_u24 v11, 3641, v9
    v_lshrrev_b32 v11, 16, v11
    v_cmp_gt_u32 vcc, s56, v9
    v_lshl_add_u32 v10, v10, 3, v11
    v_mul_u32_u24 v11, 18, v11
    v_sub_u32 v9, v9, v11
    v_cmp_gt_u32 s[44:45], 64, v10
    v_mul_u32_u24 v11, s59, v10
    v_lshl_add_u32 v9, v9, 4, v11
    s_sub_u32 s60, s39, 2048
    v_add_u32 v9, s60, v9
    s_and_b64 vcc, vcc, s[44:45]
    v_cndmask_b32 v26, v12, v9, vcc
    buffer_load_dwordx4 v26, s[64:67], s37 offen offset:2048 lds
    v_add_u32 v9, 192, v14
    v_mul_u32_u24 v10, 6899, v9
    v_lshrrev_b32 v10, 20, v10
    v_mul_u32_u24 v11, 152, v10
    v_sub_u32 v9, v9, v11
    v_mul_u32_u24 v11, 3641, v9
    v_lshrrev_b32 v11, 16, v11
    v_cmp_gt_u32 vcc, s56, v9
    v_lshl_add_u32 v10, v10, 3, v11
    v_mul_u32_u24 v11, 18, v11
    v_sub_u32 v9, v9, v11
    v_cmp_gt_u32 s[44:45], 64, v10
    v_mul_u32_u24 v11, s59, v10
    v_lshl_add_u32 v9, v9, 4, v11
    s_sub_u32 s60, s39, 3072
    v_add_u32 v9, s60, v9
    s_and_b64 vcc, vcc, s[44:45]
    v_cndmask_b32 v27, v12, v9, vcc
    buffer_load_dwordx4 v27, s[64:67], s37 offen offset:3072 lds
    v_add_u32 v9, 256, v14
    v_mul_u32_u24 v10, 6899, v9
    v_lshrrev_b32 v10, 20, v10
    v_mul_u32_u24 v11, 152, v10
    v_sub_u32 v9, v9, v11
    v_mul_u32_u24 v11, 3641, v9
    v_lshrrev_b32 v11, 16, v11
    v_cmp_gt_u32 vcc, s56, v9
    v_lshl_add_u32 v10, v10, 3, v11
    v_mul_u32_u24 v11, 18, v11
    v_sub_u32 v9, v9, v11
    v_cmp_gt_u32 s[44:45], 64, v10
    v_mul_u32_u24 v11, s59, v10
    v_lshl_add_u32 v9, v9, 4, v11
    s_sub_u32 s60, s39, 0
    v_add_u32 v9, s60, v9
    s_and_b64 vcc, vcc, s[44:45]
    s_add_u32 m0, s57, 4096
    v_cndmask_b32 v28, v12, v9, vcc
    buffer_load_dwordx4 v28, s[64:67], s37 offen offset:0 lds
    s_mov_b32 s29, s57
    s_add_u32 s96, s96, 1
    s_cmp_eq_u32 s96, 3
    s_cselect_b32 s96, 0, s96
    s_sub_u32 s98, s98, 1
    s_cmp_eq_u32 s98, 0
    s_cselect_b32 s99, 3, 0
    s_add_u32 s98, s98, s99
    s_add_u32 s97, s97, s99
    s_cmp_eq_u32 s97, 9
    s_cselect_b32 s97, 0, s97
    s_add_u32 s36, s96, s97
    s_mul_i32 s37, s36, 589824
    s_lshl_b32 s36, s36, 7
    s_add_u32 s30, s30, 36864
    s_cmp_eq_u32 s30, 147456
    s_cselect_b32 s30, 0, s30
    s_add_u32 m0, s30, s28
    s_nop 0
    buffer_load_dwordx4 v16, s[32:35], s36 offen offset:0  lds
    buffer_load_dwordx4 v17, s[32:35], s36 offen offset:1024  lds
    buffer_load_dwordx4 v18, s[32:35], s36 offen offset:2048  lds
    buffer_load_dwordx4 v19, s[32:35], s36 offen offset:3072  lds
    s_add_u32 s39, s30, s29
    s_add_u32 m0, s39, 0
    s_nop 0
    buffer_load_dwordx4 v24, s[64:67], s37 offen offset:0  lds
    buffer_load_dwordx4 v25, s[64:67], s37 offen offset:1024  lds
    buffer_load_dwordx4 v26, s[64:67], s37 offen offset:2048  lds
    buffer_load_dwordx4 v27, s[64:67], s37 offen offset:3072  lds
    s_add_u32 m0, s39, 4096
    s_nop 0
    buffer_load_dwordx4 v28, s[64:67], s37 offen offset:0  lds
    s_add_u32 s96, s96, 1
    s_cmp_eq_u32 s96, 3
    s_cselect_b32 s96, 0, s96
    s_sub_u32 s98, s98, 1
    s_cmp_eq_u32 s98, 0
    s_cselect_b32 s99, 3, 0
    s_add_u32 s98, s98, s99
    s_add_u32 s97, s97, s99
    s_cmp_eq_u32 s97, 9
    s_cselect_b32 s97, 0, s97
    s_add_u32 s36, s96, s97
    s_mul_i32 s37, s36, 589824
    s_lshl_b32 s36, s36, 7
    s_add_u32 s30, s30, 36864
    s_cmp_eq_u32 s30, 147456
    s_cselect_b32 s30, 0, s30
    s_mov_b32 s31, 2
k1_lloop:
    s_add_u32 m0, s30, s28
    s_nop 0
    buffer_load_dwordx4 v16, s[32:35], s36 offen offset:0  lds
    buffer_load_dwordx4 v17, s[32:35], s36 offen offset:1024  lds
    buffer_load_dwordx4 v18, s[32:35], s36 offen offset:2048  lds
    buffer_load_dwordx4 v19, s[32:35], s36 offen offset:3072  lds
    s_add_u32 s39, s30, s29
    s_add_u32 m0, s39, 0
    s_nop 0
    buffer_load_dwordx4 v24, s[64:67], s37 offen offset:0  lds
    buffer_load_dwordx4 v25, s[64:67], s37 offen offset:1024  lds
    buffer_load_dwordx4 v26, s[64:67], s37 offen offset:2048  lds
    buffer_load_dwordx4 v27, s[64:67], s37 offen offset:3072  lds
    s_add_u32 m0, s39, 4096
    s_nop 0
    buffer_load_dwordx4 v28, s[64:67], s37 offen offset:0  lds
    s_add_u32 s96, s96, 1
    s_cmp_eq_u32 s96, 3
    s_cselect_b32 s96, 0, s96
    s_sub_u32 s98, s98, 1
    s_cmp_eq_u32 s98, 0
    s_cselect_b32 s99, 3, 0
    s_add_u32 s98, s98, s99
    s_add_u32 s97, s97, s99
    s_cmp_eq_u32 s97, 9
    s_cselect_b32 s97, 0, s97
    s_add_u32 s36, s96, s97
    s_mul_i32 s37, s36, 589824
    s_lshl_b32 s36, s36, 7
    s_add_u32 s30, s30, 36864
    s_cmp_eq_u32 s30, 147456
    s_cselect_b32 s30, 0, s30
    s_waitcnt vmcnt(18)
    s_barrier
    s_add_u32 s31, s31, 1
    s_cmp_lg_u32 s31, 9
    s_cbranch_scc1 k1_lsame
    v_subrev_u32 v24, 4608, v24
    v_subrev_u32 v25, 4608, v25
    v_subrev_u32 v26, 4608, v26
    v_subrev_u32 v27, 4608, v27
    v_subrev_u32 v28, 4608, v28
k1_lsame:
    s_cmp_lt_u32 s31, 18
    s_cbranch_scc1 k1_lloop
    v_lshlrev_b32 v6, 12, v13
    v_xor_b32 v9, 0, v8
    v_lshl_add_u32 v9, v9, 4, v6
    v_add_u32 v16, 0, v9
    v_xor_b32 v9, 2, v8
    v_lshl_add_u32 v9, v9, 4, v6
    v_add_u32 v17, 31744, v9
    v_xor_b32 v9, 4, v8
    v_lshl_add_u32 v9, v9, 4, v6
    v_add_u32 v18, 63488, v9
    v_xor_b32 v9, 6, v8
    v_lshl_add_u32 v9, v9, 4, v6
    v_add_u32 v19, 95232, v9
    s_mul_i32 s38, s23, 589824
    s_mul_i32 s39, s27, 5120
    s_add_u32 s38, s38, s39
    v_lshlrev_b32 v9, 4, v1
    v_add_u32 v9, s38, v9
    s_cmp_eq_u32 s27, 3
    s_cselect_b64 vcc, -1, 0
    v_mov_b32 v24, v9
    v_mov_b32 v25, v9
    v_mov_b32 v26, v9
    v_cndmask_b32 v27, v9, v12, vcc
    v_add_u32 v9, 4096, v9
    v_cndmask_b32 v28, v9, v12, vcc
    s_mov_b32 s32, s8
    s_mov_b32 s33, s9
    s_mov_b32 s34, 0x800000
    s_mov_b32 s35, 0x20000
    s_add_u32 s64, s18, 0x1000000
    s_addc_u32 s65, s19, 0
    s_mov_b32 s66, 0x900000
    s_mov_b32 s67, 0x20000
    s_mov_b32 s48, s16
    s_mov_b32 s49, s17
    s_mov_b32 s50, 0x100
    s_mov_b32 s51, 0x20000
    s_add_u32 s68, s18, 0x3100000
    s_addc_u32 s69, s19, 0
    s_mov_b32 s70, 0x40000
    s_mov_b32 s71, 0x20000
    s_add_u32 s96, s53, s54
    s_and_b32 s96, s96, 3
    s_mul_i32 s96, s96, 1
    s_lshl_b32 s97, s52, 3
    s_mov_b32 s98, s97
    s_xor_b32 s36, s97, s96
    s_mul_i32 s37, s36, 18432
    s_lshl_b32 s36, s36, 7
    buffer_load_dword v11, off, s[48:51], 0 sc1
    s_add_u32 m0, s30, s28
    s_nop 0
    buffer_load_dwordx4 v16, s[32:35], s36 offen offset:0  lds
    buffer_load_dwordx4 v17, s[32:35], s36 offen offset:1024  lds
    buffer_load_dwordx4 v18, s[32:35], s36 offen offset:2048  lds
    buffer_load_dwordx4 v19, s[32:35], s36 offen offset:3072  lds
    s_add_u32 s97, s97, 1
    s_and_b32 s97, s97, 31
    s_xor_b32 s36, s97, s96
    s_lshl_b32 s36, s36, 7
    s_add_u32 s30, s30, 36864
    s_cmp_eq_u32 s30, 147456
    s_cselect_b32 s30, 0, s30
    s_waitcnt vmcnt(14)
    s_barrier
    s_add_u32 m0, s30, s28
    s_nop 0
    buffer_load_dwordx4 v16, s[32:35], s36 offen offset:0  lds
    buffer_load_dwordx4 v17, s[32:35], s36 offen offset:1024  lds
    buffer_load_dwordx4 v18, s[32:35], s36 offen offset:2048  lds
    buffer_load_dwordx4 v19, s[32:35], s36 offen offset:3072  lds
    s_add_u32 s97, s97, 1
    s_and_b32 s97, s97, 31
    s_xor_b32 s36, s97, s96
    s_lshl_b32 s36, s36, 7
    s_add_u32 s30, s30, 36864
    s_cmp_eq_u32 s30, 147456
    s_cselect_b32 s30, 0, s30
    s_waitcnt vmcnt(9)
    s_barrier
    s_add_u32 m0, s30, s28
    s_nop 0
    buffer_load_dwordx4 v16, s[32:35], s36 offen offset:0  lds
    buffer_load_dwordx4 v17, s[32:35], s36 offen offset:1024  lds
    buffer_load_dwordx4 v18, s[32:35], s36 offen offset:2048  lds
    buffer_load_dwordx4 v19, s[32:35], s36 offen offset:3072  lds
    s_add_u32 s97, s97, 1
    s_and_b32 s97, s97, 31
    s_xor_b32 s36, s97, s96
    s_lshl_b32 s36, s36, 7
    s_add_u32 s30, s30, 36864
    s_cmp_eq_u32 s30, 147456
    s_cselect_b32 s30, 0, s30
    s_barrier
    s_lshl_b32 s38, s23, 10
    v_lshlrev_b32 v10, 4, v1
    s_mov_b32 s73, 0
    s_branch kz_poll
kz_again:
    s_sleep 4
    buffer_load_dword v11, off, s[48:51], 0 sc1
kz_poll:
    buffer_load_dword v9, v10, s[68:71], s38 offen sc1
    s_waitcnt vmcnt(0)
    v_cmp_ne_u32 vcc, v11, v9
    v_cmp_eq_u32 s[44:45], 0, v11
    s_add_u32 s73, s73, 1
    s_nop 3
    s_or_b64 vcc, vcc, s[44:45]
    s_cbranch_scc0 kz_ok
    s_cmp_lt_u32 s73, 262144
    s_cbranch_scc1 kz_again
kz_ok:
    s_add_u32 m0, s30, s28
    s_nop 0
    buffer_load_dwordx4 v16, s[32:35], s36 offen offset:0  lds
    buffer_load_dwordx4 v17, s[32:35], s36 offen offset:1024  lds
    buffer_load_dwordx4 v18, s[32:35], s36 offen offset:2048  lds
    buffer_load_dwordx4 v19, s[32:35], s36 offen offset:3072  lds
    s_add_u32 s97, s97, 1
    s_and_b32 s97, s97, 31
    s_xor_b32 s36, s97, s96
    s_lshl_b32 s36, s36, 7
    s_add_u32 s30, s30, 36864
    s_cmp_eq_u32 s30, 147456
    s_cselect_b32 s30, 0, s30
    s_add_u32 s39, s30, s29
    s_add_u32 m0, s39, 0
    s_nop 0
    buffer_load_dwordx4 v24, s[64:67], s37 offen offset:0 sc1 lds
    buffer_load_dwordx4 v25, s[64:67], s37 offen offset:1024 sc1 lds
    buffer_load_dwordx4 v26, s[64:67], s37 offen offset:2048 sc1 lds
    buffer_load_dwordx4 v27, s[64:67], s37 offen offset:3072 sc1 lds
    s_add_u32 m0, s39, 4096
    s_nop 0
    buffer_load_dwordx4 v28, s[64:67], s37 offen offset:0 sc1 lds
    s_add_u32 s98, s98, 1
    s_and_b32 s98, s98, 31
    s_xor_b32 s37, s98, s96
    s_mul_i32 s37, s37, 18432
    s_add_u32 s30, s30, 36864
    s_cmp_eq_u32 s30, 147456
    s_cselect_b32 s30, 0, s30
    s_add_u32 s39, s30, s29
    s_add_u32 m0, s39, 0
    s_nop 0
    buffer_load_dwordx4 v24, s[64:67], s37 offen offset:0 sc1 lds
    buffer_load_dwordx4 v25, s[64:67], s37 offen offset:1024 sc1 lds
    buffer_load_dwordx4 v26, s[64:67], s37 offen offset:2048 sc1 lds
    buffer_load_dwordx4 v27, s[64:67], s37 offen offset:3072 sc1 lds
    s_add_u32 m0, s39, 4096
    s_nop 0
    buffer_load_dwordx4 v28, s[64:67], s37 offen offset:0 sc1 lds
    s_add_u32 s98, s98, 1
    s_and_b32 s98, s98, 31
    s_xor_b32 s37, s98, s96
    s_mul_i32 s37, s37, 18432
    s_add_u32 s30, s30, 36864
    s_cmp_eq_u32 s30, 147456
    s_cselect_b32 s30, 0, s30
    s_add_u32 s39, s30, s29
    s_add_u32 m0, s39, 0
    s_nop 0
    buffer_load_dwordx4 v24, s[64:67], s37 offen offset:0 sc1 lds
    buffer_load_dwordx4 v25, s[64:67], s37 offen offset:1024 sc1 lds
    buffer_load_dwordx4 v26, s[64:67], s37 offen offset:2048 sc1 lds
    buffer_load_dwordx4 v27, s[64:67], s37 offen offset:3072 sc1 lds
    s_add_u32 m0, s39, 4096
    s_nop 0
    buffer_load_dwordx4 v28, s[64:67], s37 offen offset:0 sc1 lds
    s_add_u32 s98, s98, 1
    s_and_b32 s98, s98, 31
    s_xor_b32 s37, s98, s96
    s_mul_i32 s37, s37, 18432
    s_add_u32 s30, s30, 36864
    s_cmp_eq_u32 s30, 147456
    s_cselect_b32 s30, 0, s30
    s_add_u32 s39, s30, s29
    s_add_u32 m0, s39, 0
    s_nop 0
    buffer_load_dwordx4 v24, s[64:67], s37 offen offset:0 sc1 lds
    buffer_load_dwordx4 v25, s[64:67], s37 offen offset:1024 sc1 lds
    buffer_load_dwordx4 v26, s[64:67], s37 offen offset:2048 sc1 lds
    buffer_load_dwordx4 v27, s[64:67], s37 offen offset:3072 sc1 lds
    s_add_u32 m0, s39, 4096
    s_nop 0
    buffer_load_dwordx4 v28, s[64:67], s37 offen offset:0 sc1 lds
    s_add_u32 s98, s98, 1
    s_and_b32 s98, s98, 31
    s_xor_b32 s37, s98, s96
    s_mul_i32 s37, s37, 18432
    s_add_u32 s30, s30, 36864
    s_cmp_eq_u32 s30, 147456
    s_cselect_b32 s30, 0, s30
    s_waitcnt vmcnt(15)
    s_barrier
    s_waitcnt vmcnt(10)
    s_barrier
    s_add_u32 m0, s30, s28
    s_nop 0
    buffer_load_dwordx4 v16, s[32:35], s36 offen offset:0  lds
    buffer_load_dwordx4 v17, s[32:35], s36 offen offset:1024  lds
    buffer_load_dwordx4 v18, s[32:35], s36 offen offset:2048  lds
    buffer_load_dwordx4 v19, s[32:35], s36 offen offset:3072  lds
    s_add_u32 s39, s30, s29
    s_add_u32 m0, s39, 0
    s_nop 0
    buffer_load_dwordx4 v24, s[64:67], s37 offen offset:0 sc1 lds
    buffer_load_dwordx4 v25, s[64:67], s37 offen offset:1024 sc1 lds
    buffer_load_dwordx4 v26, s[64:67], s37 offen offset:2048 sc1 lds
    buffer_load_dwordx4 v27, s[64:67], s37 offen offset:3072 sc1 lds
    s_add_u32 m0, s39, 4096
    s_nop 0
    buffer_load_dwordx4 v28, s[64:67], s37 offen offset:0 sc1 lds
    s_add_u32 s97, s97, 1
    s_and_b32 s97, s97, 31
    s_xor_b32 s36, s97, s96
    s_lshl_b32 s36, s36, 7
    s_add_u32 s98, s98, 1
    s_and_b32 s98, s98, 31
    s_xor_b32 s37, s98, s96
    s_mul_i32 s37, s37, 18432
    s_add_u32 s30, s30, 36864
    s_cmp_eq_u32 s30, 147456
    s_cselect_b32 s30, 0, s30
    s_waitcnt vmcnt(14)
    s_barrier
    s_mov_b32 s31, 5
    s_cmp_eq_u32 s27, 3
    s_cbranch_scc1 k2_lloop3
k2_lloop:
    s_add_u32 m0, s30, s28
    s_nop 0
    buffer_load_dwordx4 v16, s[32:35], s36 offen offset:0  lds
    buffer_load_dwordx4 v17, s[32:35], s36 offen offset:1024  lds
    buffer_load_dwordx4 v18, s[32:35], s36 offen offset:2048  lds
    buffer_load_dwordx4 v19, s[32:35], s36 offen offset:3072  lds
    s_add_u32 s39, s30, s29
    s_add_u32 m0, s39, 0
    s_nop 0
    buffer_load_dwordx4 v24, s[64:67], s37 offen offset:0 sc1 lds
    buffer_load_dwordx4 v25, s[64:67], s37 offen offset:1024 sc1 lds
    buffer_load_dwordx4 v26, s[64:67], s37 offen offset:2048 sc1 lds
    buffer_load_dwordx4 v27, s[64:67], s37 offen offset:3072 sc1 lds
    s_add_u32 m0, s39, 4096
    s_nop 0
    buffer_load_dwordx4 v28, s[64:67], s37 offen offset:0 sc1 lds
    s_add_u32 s97, s97, 1
    s_and_b32 s97, s97, 31
    s_xor_b32 s36, s97, s96
    s_lshl_b32 s36, s36, 7
    s_add_u32 s98, s98, 1
    s_and_b32 s98, s98, 31
    s_xor_b32 s37, s98, s96
    s_mul_i32 s37, s37, 18432
    s_add_u32 s30, s30, 36864
    s_cmp_eq_u32 s30, 147456
    s_cselect_b32 s30, 0, s30
    s_waitcnt vmcnt(18)
    s_barrier
    s_add_u32 s31, s31, 1
    s_cmp_lt_u32 s31, 32
    s_cbranch_scc1 k2_lloop
    s_branch k2_ldone
k2_lloop3:
    s_add_u32 m0, s30, s28
    s_nop 0
    buffer_load_dwordx4 v16, s[32:35], s36 offen offset:0  lds
    buffer_load_dwordx4 v17, s[32:35], s36 offen offset:1024  lds
    buffer_load_dwordx4 v18, s[32:35], s36 offen offset:2048  lds
    buffer_load_dwordx4 v19, s[32:35], s36 offen offset:3072  lds
    s_add_u32 s39, s30, s29
    s_add_u32 m0, s39, 0
    s_nop 0
    buffer_load_dwordx4 v24, s[64:67], s37 offen offset:0 sc1 lds
    buffer_load_dwordx4 v25, s[64:67], s37 offen offset:1024 sc1 lds
    buffer_load_dwordx4 v26, s[64:67], s37 offen offset:2048 sc1 lds
    s_add_u32 s97, s97, 1
    s_and_b32 s97, s97, 31
    s_xor_b32 s36, s97, s96
    s_lshl_b32 s36, s36, 7
    s_add_u32 s98, s98, 1
    s_and_b32 s98, s98, 31
    s_xor_b32 s37, s98, s96
    s_mul_i32 s37, s37, 18432
    s_add_u32 s30, s30, 36864
    s_cmp_eq_u32 s30, 147456
    s_cselect_b32 s30, 0, s30
    s_waitcnt vmcnt(14)
    s_barrier
    s_add_u32 s31, s31, 1
    s_cmp_lt_u32 s31, 32
    s_cbranch_scc1 k2_lloop3
    s_waitcnt vmcnt(7)
k2_ldone:
    s_and_b32 s58, s20, 1
    s_lshl_b32 s55, s58, 2
    s_add_u32 s55, s55, s52
    s_mul_i32 s55, s55, 30
    s_add_u32 s55, s55, s21
    s_cmp_ge_u32 s21, 30
    s_cselect_b32 s55, 255, s55
    s_lshl_b32 s58, s58, 1
    s_lshl_b32 s59, s52, 2
    s_add_u32 s58, s58, s59
    s_mul_i32 s56, s55, 7282
    s_lshr_b32 s56, s56, 16
    s_mul_i32 s57, s56, 9
    s_sub_u32 s57, s55, s57
    s_mul_i32 s28, s27, 384
    s_mov_b32 s29, 0xe38e39
    s_mov_b32 s36, 73728
    s_mul_i32 s37, s56, 368640
    s_movk_i32 s38, 288
    s_movk_i32 s39, 1440
    v_add_u32 v6, 0, v1
    v_add_u32 v6, s28, v6
    v_mul_hi_u32 v7, v6, s29
    v_mul_lo_u32 v8, v7, s38
    v_sub_u32 v8, v6, v8
    v_mul_lo_u32 v7, v7, s36
    v_lshl_add_u32 v7, v8, 4, v7
    v_add_u32 v7, s37, v7
    v_cmp_gt_u32 vcc, s39, v6
    v_subrev_u32 v7, 0, v7
    s_nop 0
    v_cndmask_b32 v16, v12, v7, vcc
    v_add_u32 v6, 64, v1
    v_add_u32 v6, s28, v6
    v_mul_hi_u32 v7, v6, s29
    v_mul_lo_u32 v8, v7, s38
    v_sub_u32 v8, v6, v8
    v_mul_lo_u32 v7, v7, s36
    v_lshl_add_u32 v7, v8, 4, v7
    v_add_u32 v7, s37, v7
    v_cmp_gt_u32 vcc, s39, v6
    v_subrev_u32 v7, 1024, v7
    s_nop 0
    v_cndmask_b32 v17, v12, v7, vcc
    v_add_u32 v6, 128, v1
    v_add_u32 v6, s28, v6
    v_mul_hi_u32 v7, v6, s29
    v_mul_lo_u32 v8, v7, s38
    v_sub_u32 v8, v6, v8
    v_mul_lo_u32 v7, v7, s36
    v_lshl_add_u32 v7, v8, 4, v7
    v_add_u32 v7, s37, v7
    v_cmp_gt_u32 vcc, s39, v6
    v_subrev_u32 v7, 2048, v7
    s_nop 0
    v_cndmask_b32 v18, v12, v7, vcc
    v_add_u32 v6, 192, v1
    v_add_u32 v6, s28, v6
    v_mul_hi_u32 v7, v6, s29
    v_mul_lo_u32 v8, v7, s38
    v_sub_u32 v8, v6, v8
    v_mul_lo_u32 v7, v7, s36
    v_lshl_add_u32 v7, v8, 4, v7
    v_add_u32 v7, s37, v7
    v_cmp_gt_u32 vcc, s39, v6
    v_subrev_u32 v7, 3072, v7
    s_nop 0
    v_cndmask_b32 v19, v12, v7, vcc
    v_add_u32 v6, 256, v1
    v_add_u32 v6, s28, v6
    v_mul_hi_u32 v7, v6, s29
    v_mul_lo_u32 v8, v7, s38
    v_sub_u32 v8, v6, v8
    v_mul_lo_u32 v7, v7, s36
    v_lshl_add_u32 v7, v8, 4, v7
    v_add_u32 v7, s37, v7
    v_cmp_gt_u32 vcc, s39, v6
    v_subrev_u32 v7, 0, v7
    s_nop 0
    v_cndmask_b32 v20, v12, v7, vcc
    v_add_u32 v6, 320, v1
    v_add_u32 v6, s28, v6
    v_mul_hi_u32 v7, v6, s29
    v_mul_lo_u32 v8, v7, s38
    v_sub_u32 v8, v6, v8
    v_mul_lo_u32 v7, v7, s36
    v_lshl_add_u32 v7, v8, 4, v7
    v_add_u32 v7, s37, v7
    v_cmp_gt_u32 vcc, s39, v6
    v_subrev_u32 v7, 1024, v7
    s_nop 0
    v_cndmask_b32 v21, v12, v7, vcc
    s_waitcnt vmcnt(9)
    s_barrier
    v_and_b32 v6, 6, v4
    v_xor_b32 v6, v5, v6
    v_lshlrev_b32 v6, 4, v6
    s_mul_i32 s28, s27, 40
    v_add_u32 v7, s28, v4
    s_movk_i32 s28, 1152
    v_mul_lo_u32 v7, v7, s28
    v_add_u32 v7, v7, v6
    s_lshl_b32 s28, s57, 7
    v_add_u32 v7, s28, v7
    s_cmp_eq_u32 s27, 3
    s_cselect_b64 vcc, -1, 0
    v_add_u32 v24, 0, v7
    v_add_u32 v25, 8192, v7
    v_add_u32 v26, 16384, v7
    v_add_u32 v27, 24576, v7
    v_cndmask_b32 v27, v27, v12, vcc
    v_add_u32 v28, 36864, v7
    v_cndmask_b32 v28, v28, v12, vcc
    s_add_u32 s32, s18, 0x2000000
    s_addc_u32 s33, s19, 0
    s_mov_b32 s34, 0x900000
    s_mov_b32 s35, 0x20000
    s_mov_b32 s64, s12
    s_mov_b32 s65, s13
    s_mov_b32 s66, 0x288000
    s_mov_b32 s67, 0x20000
    s_mul_i32 s28, s27, 6144
    s_mul_i32 s29, s27, 5120
    s_add_u32 s29, s29, 24576
    s_waitcnt vmcnt(0)
    s_barrier
    s_barrier
    s_barrier
    s_cmp_ge_u32 s55, 234
    s_cbranch_scc1 kl_done
    s_mov_b32 s30, 0
    s_mul_i32 s36, s58, 4608
    s_mul_i32 s37, s58, 165888
    s_add_u32 s39, s30, s29
    s_add_u32 m0, s39, 0
    s_nop 0
    buffer_load_dwordx4 v24, s[64:67], s37 offen offset:0  lds
    buffer_load_dwordx4 v25, s[64:67], s37 offen offset:1024  lds
    buffer_load_dwordx4 v26, s[64:67], s37 offen offset:2048  lds
    buffer_load_dwordx4 v27, s[64:67], s37 offen offset:3072  lds
    s_add_u32 m0, s39, 4096
    s_nop 0
    buffer_load_dwordx4 v28, s[64:67], s37 offen offset:0  lds
    s_add_u32 s37, s37, 165888
    s_cmp_eq_u32 s37, 2654208
    s_cselect_b32 s37, 0, s37
    s_add_u32 s30, s30, 45056
    s_cmp_eq_u32 s30, 135168
    s_cselect_b32 s30, 0, s30
    s_add_u32 s39, s30, s29
    s_add_u32 m0, s39, 0
    s_nop 0
    buffer_load_dwordx4 v24, s[64:67], s37 offen offset:0  lds
    buffer_load_dwordx4 v25, s[64:67], s37 offen offset:1024  lds
    buffer_load_dwordx4 v26, s[64:67], s37 offen offset:2048  lds
    buffer_load_dwordx4 v27, s[64:67], s37 offen offset:3072  lds
    s_add_u32 m0, s39, 4096
    s_nop 0
    buffer_load_dwordx4 v28, s[64:67], s37 offen offset:0  lds
    s_add_u32 s37, s37, 165888
    s_cmp_eq_u32 s37, 2654208
    s_cselect_b32 s37, 0, s37
    s_add_u32 s30, s30, 45056
    s_cmp_eq_u32 s30, 135168
    s_cselect_b32 s30, 0, s30
    s_add_u32 s39, s30, s29
    s_add_u32 m0, s39, 0
    s_nop 0
    buffer_load_dwordx4 v24, s[64:67], s37 offen offset:0  lds
    buffer_load_dwordx4 v25, s[64:67], s37 offen offset:1024  lds
    buffer_load_dwordx4 v26, s[64:67], s37 offen offset:2048  lds
    buffer_load_dwordx4 v27, s[64:67], s37 offen offset:3072  lds
    s_add_u32 m0, s39, 4096
    s_nop 0
    buffer_load_dwordx4 v28, s[64:67], s37 offen offset:0  lds
    s_add_u32 s37, s37, 165888
    s_cmp_eq_u32 s37, 2654208
    s_cselect_b32 s37, 0, s37
    s_add_u32 s30, s30, 45056
    s_cmp_eq_u32 s30, 135168
    s_cselect_b32 s30, 0, s30
    s_barrier
    s_barrier
    s_add_u32 s38, s30, s28
    s_add_u32 m0, s38, 0
    s_nop 0
    buffer_load_dwordx4 v16, s[32:35], s36 offen offset:0 sc1 lds
    buffer_load_dwordx4 v17, s[32:35], s36 offen offset:1024 sc1 lds
    buffer_load_dwordx4 v18, s[32:35], s36 offen offset:2048 sc1 lds
    buffer_load_dwordx4 v19, s[32:35], s36 offen offset:3072 sc1 lds
    s_add_u32 m0, s38, 4096
    s_nop 0
    buffer_load_dwordx4 v20, s[32:35], s36 offen offset:0 sc1 lds
    buffer_load_dwordx4 v21, s[32:35], s36 offen offset:1024 sc1 lds
    s_add_u32 s36, s36, 4608
    s_cmp_eq_u32 s36, 73728
    s_cselect_b32 s36, 0, s36
    s_add_u32 s30, s30, 45056
    s_cmp_eq_u32 s30, 135168
    s_cselect_b32 s30, 0, s30
    s_add_u32 s38, s30, s28
    s_add_u32 m0, s38, 0
    s_nop 0
    buffer_load_dwordx4 v16, s[32:35], s36 offen offset:0 sc1 lds
    buffer_load_dwordx4 v17, s[32:35], s36 offen offset:1024 sc1 lds
    buffer_load_dwordx4 v18, s[32:35], s36 offen offset:2048 sc1 lds
    buffer_load_dwordx4 v19, s[32:35], s36 offen offset:3072 sc1 lds
    s_add_u32 m0, s38, 4096
    s_nop 0
    buffer_load_dwordx4 v20, s[32:35], s36 offen offset:0 sc1 lds
    buffer_load_dwordx4 v21, s[32:35], s36 offen offset:1024 sc1 lds
    s_add_u32 s36, s36, 4608
    s_cmp_eq_u32 s36, 73728
    s_cselect_b32 s36, 0, s36
    s_add_u32 s30, s30, 45056
    s_cmp_eq_u32 s30, 135168
    s_cselect_b32 s30, 0, s30
    s_add_u32 s38, s30, s28
    s_add_u32 m0, s38, 0
    s_nop 0
    buffer_load_dwordx4 v16, s[32:35], s36 offen offset:0 sc1 lds
    buffer_load_dwordx4 v17, s[32:35], s36 offen offset:1024 sc1 lds
    buffer_load_dwordx4 v18, s[32:35], s36 offen offset:2048 sc1 lds
    buffer_load_dwordx4 v19, s[32:35], s36 offen offset:3072 sc1 lds
    s_add_u32 m0, s38, 4096
    s_nop 0
    buffer_load_dwordx4 v20, s[32:35], s36 offen offset:0 sc1 lds
    buffer_load_dwordx4 v21, s[32:35], s36 offen offset:1024 sc1 lds
    s_add_u32 s36, s36, 4608
    s_cmp_eq_u32 s36, 73728
    s_cselect_b32 s36, 0, s36
    s_add_u32 s30, s30, 45056
    s_cmp_eq_u32 s30, 135168
    s_cselect_b32 s30, 0, s30
    s_waitcnt vmcnt(12)
    s_barrier
    s_waitcnt vmcnt(6)
    s_barrier
    s_mov_b32 s31, 3
k3_lloop:
    s_add_u32 s39, s30, s29
    s_add_u32 m0, s39, 0
    s_nop 0
    buffer_load_dwordx4 v24, s[64:67], s37 offen offset:0  lds
    buffer_load_dwordx4 v25, s[64:67], s37 offen offset:1024  lds
    buffer_load_dwordx4 v26, s[64:67], s37 offen offset:2048  lds
    buffer_load_dwordx4 v27, s[64:67], s37 offen offset:3072  lds
    s_add_u32 m0, s39, 4096
    s_nop 0
    buffer_load_dwordx4 v28, s[64:67], s37 offen offset:0  lds
    s_add_u32 s37, s37, 165888
    s_cmp_eq_u32 s37, 2654208
    s_cselect_b32 s37, 0, s37
    s_add_u32 s38, s30, s28
    s_add_u32 m0, s38, 0
    s_nop 0
    buffer_load_dwordx4 v16, s[32:35], s36 offen offset:0 sc1 lds
    buffer_load_dwordx4 v17, s[32:35], s36 offen offset:1024 sc1 lds
    buffer_load_dwordx4 v18, s[32:35], s36 offen offset:2048 sc1 lds
    buffer_load_dwordx4 v19, s[32:35], s36 offen offset:3072 sc1 lds
    s_add_u32 m0, s38, 4096
    s_nop 0
    buffer_load_dwordx4 v20, s[32:35], s36 offen offset:0 sc1 lds
    buffer_load_dwordx4 v21, s[32:35], s36 offen offset:1024 sc1 lds
    s_add_u32 s36, s36, 4608
    s_cmp_eq_u32 s36, 73728
    s_cselect_b32 s36, 0, s36
    s_add_u32 s30, s30, 45056
    s_cmp_eq_u32 s30, 135168
    s_cselect_b32 s30, 0, s30
    s_waitcnt vmcnt(11)
    s_barrier
    s_add_u32 s31, s31, 1
    s_cmp_lt_u32 s31, 16
    s_cbranch_scc1 k3_lloop
    s_waitcnt vmcnt(0)
    s_barrier
kl_done:
k_end:
    s_endpgm
    .p2align 8
text_pad:
    .fill 2560, 4, 0xBF810000
.section .rodata,"a"
.p2align 6
.amdhsa_kernel standalone__mixer_gmlp__prompt_kernel
  .amdhsa_next_free_vgpr 256
  .amdhsa_next_free_sgpr 102
  .amdhsa_accum_offset 256
  .amdhsa_group_segment_fixed_size 0
  .amdhsa_kernarg_size 64
  .amdhsa_user_sgpr_count 2
  .amdhsa_user_sgpr_kernarg_segment_ptr 1
  .amdhsa_system_sgpr_workgroup_id_x 1
.end_amdhsa_kernel
```
